```python
import torch

def _softmax(x, axis=-1):
    return torch.softmax(x, dim=axis)
def _gelu(x):
    return torch.nn.functional.gelu(x, approximate="tanh")
def _silu(x):
    return torch.nn.functional.silu(x)
def _sigmoid(x):
    return torch.sigmoid(x)
def _layernorm(x, axis=-1, eps=1e-5):
    m = x.mean(dim=axis, keepdim=True)
    v = x.var(dim=axis, keepdim=True, unbiased=False)
    return (x - m) / torch.sqrt(v + eps)
def _scatter_add(tgt, idx, src, axis=0):
    return tgt.clone().index_add_(axis, idx, src)
def _segment_sum(src, seg, n):
    out = torch.zeros((n,) + src.shape[1:], dtype=src.dtype)
    return out.index_add_(0, seg, src)
def _pad(x, pw):
    flat = tuple(v for pair in reversed(pw) for v in pair)
    return torch.nn.functional.pad(x, flat)

kernel_name = 'standalone__gqa_softmax__prompt'

def setup_inputs():

    _w = (lambda a: (lambda t: t.to(torch.bfloat16) if t.is_floating_point() else t)(torch.as_tensor(a)))
    B, Hq, Hkv, Sq, Sk, D = 1, 32, 8, 2048, 2048, 128
    return {
        "q": _w((lambda *s: torch.randn(*s, dtype=torch.bfloat16) * 0.8)(B, Hq, Sq, D)),
        "k": _w((lambda *s: torch.randn(*s, dtype=torch.bfloat16) * 0.8)(B, Hkv, Sk, D)),
        "v": _w((lambda *s: torch.randn(*s, dtype=torch.bfloat16) * 0.05)(B, Hkv, Sk, D)),
    }

def reference(q, k, v):
    B, Hq, Sq, D = q.shape
    Hkv = k.shape[1]
    rep = Hq // Hkv
    k = (lambda x, n, axis: torch.repeat_interleave(x, n, dim=axis))(k, rep, axis=1)
    v = (lambda x, n, axis: torch.repeat_interleave(x, n, dim=axis))(v, rep, axis=1)
    scale = D ** -0.5
    scores = torch.einsum("bhqd,bhkd->bhqk", q, k) * scale
    p = _softmax(scores, axis=-1)
    return torch.einsum("bhqk,bhkd->bhqd", p, v)
```

```asm
; @launch grid=(256,1,1) block=(256,1,1) lds=163840
.amdgcn_target "amdgcn-amd-amdhsa--gfx950"
.text
.globl standalone__gqa_softmax__prompt_kernel
.p2align 8
.type standalone__gqa_softmax__prompt_kernel,@function
standalone__gqa_softmax__prompt_kernel:
  s_cmp_ge_u32 s2, 0x100
  s_cbranch_scc1 L_end
  s_load_dwordx4 s[4:7], s[0:1], 0
  s_load_dwordx4 s[8:11], s[0:1], 16
  s_getpc_b64 s[54:55]
L_pc:
  v_lshlrev_b32 v7, 7, v0
  v_min_u32 v7, L_slow-L_pc, v7
  s_cmp_lt_u32 s2, 16
  s_cselect_b32 s56, -1, 0
  v_and_b32 v7, s56, v7
  global_load_dword v7, v7, s[54:55]
  v_lshrrev_b32 v3, 6, v0
  v_and_b32 v1, 15, v0
  v_bfe_u32 v2, v0, 4, 2
  v_readfirstlane_b32 s38, v3
  v_xor_b32 v4, v1, v2
  v_lshlrev_b32 v5, 12, v3
  v_lshl_add_u32 v5, v2, 8, v5
  v_lshl_add_u32 v44, v4, 4, v5
  s_and_b32 s46, s2, 7
  s_lshr_b32 s47, s2, 3
  s_lshl_b32 s48, s46, 21
  s_lshl_b32 s47, s47, 16
  s_add_u32 s48, s48, s47
  s_lshl_b32 s46, s46, 19
  v_xor_b32 v45, 64, v44
  v_xor_b32 v46, 128, v44
  v_xor_b32 v47, 192, v44
  v_mul_u32_u24 v6, 0x3000, v3
  v_add_u32 v16, v6, v44
  v_add_u32 v17, v6, v45
  v_add_u32 v18, v6, v46
  v_add_u32 v19, v6, v47
  v_lshrrev_b32 v6, 1, v1
  v_xor_b32 v6, v6, v2
  v_lshl_add_u32 v6, v6, 5, v5
  v_and_b32 v8, 1, v1
  v_lshl_add_u32 v30, v8, 4, v6
  v_xor_b32 v31, 0x80, v30
  s_lshl_b32 s49, s38, 12
  s_add_u32 s28, s49, 0x0
  s_add_u32 s32, s49, 0x10000
  s_add_u32 s29, s49, 0x4000
  s_add_u32 s33, s49, 0x14000
  s_add_u32 s30, s49, 0x8000
  s_add_u32 s34, s49, 0x18000
  s_add_u32 s31, s49, 0xc000
  s_add_u32 s35, s49, 0x1c000
  s_add_u32 s52, s49, 0x18000
  s_mov_b32 s40, s49
  s_add_u32 s41, s40, 0x1000
  s_bitset0_b32 s41, 14
  s_add_u32 s42, s41, 0x1000
  s_bitset0_b32 s42, 14
  s_add_u32 s43, s42, 0x1000
  s_bitset0_b32 s43, 14
  s_mov_b32 s57, 0
  s_movk_i32 s36, 0x4000
  s_mov_b32 m0, s31
  s_mov_b32 s18, 0x80000
  s_mov_b32 s19, 0x20000
  s_mov_b32 s14, 0x10000
  s_mov_b32 s15, 0x20000
  s_mov_b32 s22, 0x80000
  s_mov_b32 s23, 0x20000
  s_mov_b32 s26, 0x10000
  s_mov_b32 s27, 0x20000
  v_lshlrev_b32 v6, 8, v1
  v_lshl_add_u32 v32, v4, 4, v6
  v_xor_b32 v33, 64, v32
  v_xor_b32 v34, 128, v32
  v_xor_b32 v35, 192, v32
  v_add_u32 v20, s52, v32
  v_add_u32 v21, s52, v33
  v_add_u32 v22, s52, v34
  v_add_u32 v23, s52, v35
  s_waitcnt lgkmcnt(0)
  s_add_u32 s16, s6, s46
  s_addc_u32 s17, s7, 0
  s_add_u32 s12, s4, s48
  s_addc_u32 s13, s5, 0
  buffer_load_dwordx4 v44, s[16:19], s57 offen offset:0 lds
  buffer_load_dwordx4 v45, s[16:19], s57 offen offset:1024 lds
  buffer_load_dwordx4 v46, s[16:19], s57 offen offset:2048 lds
  buffer_load_dwordx4 v47, s[16:19], s57 offen offset:3072 lds
  s_add_u32 m0, s52, 0x0
  s_nop 0
  buffer_load_dwordx4 v16, s[12:15], s40 offen offset:0 sc0 sc1 nt lds
  buffer_load_dwordx4 v17, s[12:15], s40 offen offset:1024 sc0 sc1 nt lds
  buffer_load_dwordx4 v18, s[12:15], s40 offen offset:2048 sc0 sc1 nt lds
  buffer_load_dwordx4 v19, s[12:15], s40 offen offset:3072 sc0 sc1 nt lds
  s_add_u32 s20, s8, s46
  s_addc_u32 s21, s9, 0
  s_mov_b32 m0, s32
  s_add_u32 s24, s10, s48
  s_addc_u32 s25, s11, 0
  buffer_load_dwordx4 v30, s[20:23], s57 offen offset:0 lds
  buffer_load_dwordx4 v31, s[20:23], s57 offen offset:1024 lds
  buffer_load_dwordx4 v30, s[20:23], s57 offen offset:2048 lds
  buffer_load_dwordx4 v31, s[20:23], s57 offen offset:3072 lds
  v_lshrrev_b32 v9, 2, v1
  v_lshlrev_b32 v10, 4, v8
  v_cmp_eq_u32 vcc, v9, v2
  v_mov_b32 v11, 0x3e03
  v_mov_b32 v12, 0xb9d8
  v_lshlrev_b32 v11, v10, v11
  v_lshlrev_b32 v12, v10, v12
  v_cndmask_b32 v11, 0, v11, vcc
  v_cndmask_b32 v12, 0, v12, vcc
  v_and_b32 v10, 2, v1
  v_cmp_eq_u32 vcc, 0, v10
  v_accvgpr_write_b32 a148, 0
  v_accvgpr_write_b32 a149, 0
  v_accvgpr_write_b32 a152, 0
  v_accvgpr_write_b32 a153, 0
  v_accvgpr_write_b32 a154, 0
  v_accvgpr_write_b32 a155, 0
  v_accvgpr_write_b32 a158, 0
  v_accvgpr_write_b32 a159, 0
  v_cndmask_b32 v13, 0, v11, vcc
  v_sub_u32 v14, v11, v13
  v_cndmask_b32 v15, 0, v12, vcc
  v_accvgpr_write_b32 a150, v13
  v_accvgpr_write_b32 a151, v14
  v_sub_u32 v14, v12, v15
  v_accvgpr_write_b32 a156, v15
  v_accvgpr_write_b32 a157, v14
  s_mov_b32 s39, 1
  s_mov_b64 s[44:45], 0
  s_mov_b32 s53, 0x5d800000
  v_lshl_add_u32 v6, v2, 2, v9
  v_and_b32 v10, 7, v6
  v_lshlrev_b32 v6, 8, v6
  v_lshl_add_u32 v6, v10, 5, v6
  v_and_b32 v10, 3, v1
  v_lshl_add_u32 v6, v10, 3, v6
  v_add_u32 v36, 0x10000, v6
  v_xor_b32 v37, 32, v36
  v_xor_b32 v38, 64, v36
  v_xor_b32 v39, 96, v36
  v_xor_b32 v40, 128, v36
  v_xor_b32 v41, 160, v36
  v_xor_b32 v42, 192, v36
  v_xor_b32 v43, 224, v36
  v_mov_b32 v6, 0x44444444
  v_cmp_eq_u32 vcc, 1, v8
  v_mov_b32 v10, 0xeeeeeeee
  v_mov_b32 v11, 0x3f803f80
  v_cndmask_b32 v29, v6, v10, vcc
  v_accvgpr_write_b32 a144, v11
  v_accvgpr_write_b32 a145, v11
  v_accvgpr_write_b32 a146, v11
  v_accvgpr_write_b32 a147, v11
  v_accvgpr_write_b32 a128, 0
  v_accvgpr_write_b32 a129, 0
  v_accvgpr_write_b32 a130, 0
  v_accvgpr_write_b32 a131, 0
  v_accvgpr_write_b32 a132, 0
  v_accvgpr_write_b32 a133, 0
  v_accvgpr_write_b32 a134, 0
  v_accvgpr_write_b32 a135, 0
  v_accvgpr_write_b32 a136, 0
  v_accvgpr_write_b32 a137, 0
  v_accvgpr_write_b32 a138, 0
  v_accvgpr_write_b32 a139, 0
  v_accvgpr_write_b32 a140, 0
  v_accvgpr_write_b32 a141, 0
  v_accvgpr_write_b32 a142, 0
  v_accvgpr_write_b32 a143, 0
  v_mov_b64 v[72:73], 0
  v_mov_b64 v[74:75], 0
  v_lshlrev_b32 v6, 13, v3
  v_add_u32 v6, 0x20000, v6
  v_mul_u32_u24 v10, 0x190, v1
  v_lshl_add_u32 v10, v2, 3, v10
  v_add_u32 v28, v6, v10
  v_bfe_u32 v11, v0, 3, 3
  v_and_b32 v12, 7, v0
  v_mul_u32_u24 v10, 0x190, v11
  v_lshl_add_u32 v10, v12, 4, v10
  v_add_u32 v24, v6, v10
  v_lshlrev_b32 v6, 8, v11
  v_lshl_add_u32 v6, v12, 4, v6
  v_lshl_add_u32 v27, v3, 14, v6
  s_mov_b32 m0, s28
  s_nop 0
  buffer_load_dwordx4 v44, s[16:19], s36 offen offset:0 lds
  buffer_load_dwordx4 v45, s[16:19], s36 offen offset:1024 lds
  buffer_load_dwordx4 v46, s[16:19], s36 offen offset:2048 lds
  buffer_load_dwordx4 v47, s[16:19], s36 offen offset:3072 lds
  s_waitcnt vmcnt(12)
  s_barrier
  s_add_u32 m0, s52, 0x4000
  ds_read_b128 a[160:163], v32 offset:49152
  buffer_load_dwordx4 v16, s[12:15], s41 offen offset:0 sc0 sc1 nt lds
  buffer_load_dwordx4 v17, s[12:15], s41 offen offset:1024 sc0 sc1 nt lds
  buffer_load_dwordx4 v18, s[12:15], s41 offen offset:2048 sc0 sc1 nt lds
  buffer_load_dwordx4 v19, s[12:15], s41 offen offset:3072 sc0 sc1 nt lds
  s_waitcnt vmcnt(12)
  ds_read_b128 a[0:3], v20 offset:0
  ds_read_b128 a[4:7], v21 offset:0
  ds_read_b128 a[8:11], v22 offset:0
  ds_read_b128 a[12:15], v23 offset:0
  ds_read_b128 a[176:179], v32 offset:53248
  ds_read_b128 a[164:167], v33 offset:49152
  ds_read_b128 a[180:183], v33 offset:53248
  ds_read_b128 a[168:171], v34 offset:49152
  ds_read_b128 a[184:187], v34 offset:53248
  ds_read_b128 a[172:175], v35 offset:49152
  ds_read_b128 a[188:191], v35 offset:53248
  ds_read_b128 a[64:67], v32 offset:57344
  ds_read_b128 a[68:71], v33 offset:57344
  ds_read_b128 a[72:75], v34 offset:57344
  ds_read_b128 a[76:79], v35 offset:57344
  ds_read_b128 a[80:83], v32 offset:61440
  ds_read_b128 a[84:87], v33 offset:61440
  ds_read_b128 a[88:91], v34 offset:61440
  ds_read_b128 a[92:95], v35 offset:61440
  s_mov_b32 s37, 0x18000
  s_mov_b32 s36, 0x14000
  s_waitcnt lgkmcnt(15)
  v_mfma_f32_16x16x32_bf16 v[128:131], a[150:153], a[0:3], 0
  v_mfma_f32_16x16x32_bf16 v[132:135], a[148:151], a[0:3], 0
  v_mfma_f32_16x16x32_bf16 v[128:131], a[156:159], a[0:3], v[128:131]
  s_mov_b32 s46, 0x8000
  s_mov_b32 m0, s29
  v_mfma_f32_16x16x32_bf16 v[132:135], a[154:157], a[0:3], v[132:135]
  buffer_load_dwordx4 v44, s[16:19], s46 offen offset:0 lds
  v_mfma_f32_16x16x32_bf16 v[136:139], a[150:153], a[4:7], 0
  buffer_load_dwordx4 v45, s[16:19], s46 offen offset:1024 lds
  v_mfma_f32_16x16x32_bf16 v[140:143], a[148:151], a[4:7], 0
  v_mfma_f32_16x16x32_bf16 v[136:139], a[156:159], a[4:7], v[136:139]
  buffer_load_dwordx4 v46, s[16:19], s46 offen offset:2048 lds
  v_cvt_pk_bf16_f32 v128, v128, v129
  v_cvt_pk_bf16_f32 v130, v130, v131
  v_cvt_pk_bf16_f32 v132, v132, v133
  v_cvt_pk_bf16_f32 v134, v134, v135
  v_accvgpr_write_b32 a0, v128
  v_mfma_f32_16x16x32_bf16 v[140:143], a[154:157], a[4:7], v[140:143]
  v_accvgpr_write_b32 a1, v130
  v_accvgpr_write_b32 a2, v132
  v_accvgpr_write_b32 a3, v134
  v_cvt_pk_bf16_f32 v136, v136, v137
  v_cvt_pk_bf16_f32 v138, v138, v139
  v_accvgpr_write_b32 a4, v136
  v_mfma_f32_16x16x32_bf16 v[144:147], a[150:153], a[8:11], 0
  buffer_load_dwordx4 v47, s[16:19], s46 offen offset:3072 lds
  v_cvt_pk_bf16_f32 v140, v140, v141
  v_cvt_pk_bf16_f32 v142, v142, v143
  v_accvgpr_write_b32 a5, v138
  v_accvgpr_write_b32 a6, v140
  v_accvgpr_write_b32 a7, v142
  v_mfma_f32_16x16x32_bf16 v[148:151], a[148:151], a[8:11], 0
  v_mfma_f32_16x16x32_bf16 v[144:147], a[156:159], a[8:11], v[144:147]
  s_mov_b32 s47, 0x4000
  s_mov_b32 m0, s33
  v_mfma_f32_16x16x32_bf16 v[148:151], a[154:157], a[8:11], v[148:151]
  buffer_load_dwordx4 v30, s[20:23], s47 offen offset:0 lds
  v_mfma_f32_16x16x32_bf16 v[152:155], a[150:153], a[12:15], 0
  buffer_load_dwordx4 v31, s[20:23], s47 offen offset:1024 lds
  v_mfma_f32_16x16x32_bf16 v[156:159], a[148:151], a[12:15], 0
  v_mfma_f32_16x16x32_bf16 v[152:155], a[156:159], a[12:15], v[152:155]
  buffer_load_dwordx4 v30, s[20:23], s47 offen offset:2048 lds
  v_cvt_pk_bf16_f32 v144, v144, v145
  v_cvt_pk_bf16_f32 v146, v146, v147
  v_cvt_pk_bf16_f32 v148, v148, v149
  v_cvt_pk_bf16_f32 v150, v150, v151
  v_accvgpr_write_b32 a8, v144
  v_mfma_f32_16x16x32_bf16 v[156:159], a[154:157], a[12:15], v[156:159]
  v_accvgpr_write_b32 a9, v146
  v_accvgpr_write_b32 a10, v148
  v_accvgpr_write_b32 a11, v150
  v_cvt_pk_bf16_f32 v152, v152, v153
  v_cvt_pk_bf16_f32 v154, v154, v155
  v_accvgpr_write_b32 a12, v152
  v_mfma_f32_16x16x32_bf16 v[96:99], a[160:163], a[0:3], 0
  buffer_load_dwordx4 v31, s[20:23], s47 offen offset:3072 lds
  v_cvt_pk_bf16_f32 v156, v156, v157
  v_cvt_pk_bf16_f32 v158, v158, v159
  v_accvgpr_write_b32 a13, v154
  v_accvgpr_write_b32 a14, v156
  v_accvgpr_write_b32 a15, v158
  s_waitcnt lgkmcnt(14)
  v_mfma_f32_16x16x32_bf16 v[100:103], a[176:179], a[0:3], 0
  s_waitcnt vmcnt(12) lgkmcnt(0)
  s_barrier
  ds_read_b64_tr_b16 v[224:225], v36 offset:0
  ds_read_b64_tr_b16 v[226:227], v36 offset:4096
  ds_read_b64_tr_b16 v[228:229], v37 offset:0
  ds_read_b64_tr_b16 v[230:231], v37 offset:4096
  v_mfma_f32_16x16x32_bf16 v[96:99], a[164:167], a[4:7], v[96:99]
  ds_read_b64_tr_b16 v[232:233], v38 offset:0
  ds_read_b64_tr_b16 v[234:235], v38 offset:4096
  ds_read_b64_tr_b16 v[236:237], v39 offset:0
  ds_read_b64_tr_b16 v[238:239], v39 offset:4096
  ds_read_b64_tr_b16 v[240:241], v40 offset:0
  ds_read_b64_tr_b16 v[242:243], v40 offset:4096
  v_mfma_f32_16x16x32_bf16 v[100:103], a[180:183], a[4:7], v[100:103]
  ds_read_b64_tr_b16 v[244:245], v41 offset:0
  ds_read_b64_tr_b16 v[246:247], v41 offset:4096
  ds_read_b64_tr_b16 v[248:249], v42 offset:0
  ds_read_b64_tr_b16 v[250:251], v42 offset:4096
  ds_read_b64_tr_b16 v[252:253], v43 offset:0
  ds_read_b64_tr_b16 v[254:255], v43 offset:4096
  v_mfma_f32_16x16x32_bf16 v[96:99], a[168:171], a[8:11], v[96:99]
  ds_read_b64_tr_b16 a[192:193], v36 offset:8192
  ds_read_b64_tr_b16 a[194:195], v36 offset:12288
  ds_read_b64_tr_b16 a[196:197], v37 offset:8192
  ds_read_b64_tr_b16 a[198:199], v37 offset:12288
  ds_read_b64_tr_b16 a[200:201], v38 offset:8192
  ds_read_b64_tr_b16 a[202:203], v38 offset:12288
  v_mfma_f32_16x16x32_bf16 v[100:103], a[184:187], a[8:11], v[100:103]
  ds_read_b64_tr_b16 a[204:205], v39 offset:8192
  ds_read_b64_tr_b16 a[206:207], v39 offset:12288
  ds_read_b64_tr_b16 a[208:209], v40 offset:8192
  ds_read_b64_tr_b16 a[210:211], v40 offset:12288
  ds_read_b64_tr_b16 a[212:213], v41 offset:8192
  s_waitcnt lgkmcnt(15)
  v_max3_f32 v8, |v224|, |v225|, |v226|
  v_mfma_f32_16x16x32_bf16 v[96:99], a[172:175], a[12:15], v[96:99]
  ds_read_b64_tr_b16 a[214:215], v41 offset:12288
  ds_read_b64_tr_b16 a[216:217], v42 offset:8192
  ds_read_b64_tr_b16 a[218:219], v42 offset:12288
  ds_read_b64_tr_b16 a[220:221], v43 offset:8192
  ds_read_b64_tr_b16 a[222:223], v43 offset:12288
  v_max_f32_e64 v8, v8, |v227|
  v_mfma_f32_16x16x32_bf16 v[100:103], a[188:191], a[12:15], v[100:103]
  ds_read_b128 a[160:163], v32 offset:0
  ds_read_b128 a[164:167], v33 offset:0
  ds_read_b128 a[168:171], v34 offset:0
  ds_read_b128 a[172:175], v35 offset:0
  ds_read_b128 a[176:179], v32 offset:4096
  v_max3_f32 v4, v96, v97, v98
  v_max3_f32 v9, |v228|, |v229|, |v230|
  v_max_f32_e64 v9, v9, |v231|
  v_max3_f32 v5, v99, v100, v101
  v_max3_f32 v4, v4, v102, v103
  v_max_f32 v4, v4, v5
  v_mov_b32 v5, v4
  v_max3_f32 v10, |v232|, |v233|, |v234|
  v_max_f32_e64 v10, v10, |v235|
  v_permlane32_swap_b32 v4, v5
  v_max_f32 v4, v4, v5
  v_mov_b32 v5, v4
  v_max3_f32 v11, |v236|, |v237|, |v238|
  v_max_f32_e64 v11, v11, |v239|
  v_permlane16_swap_b32 v4, v5
  v_max_f32 v4, v4, v5
  v_sub_f32 v48, 0xc0600000, v4
  v_add_f32 v96, v96, v48
  v_add_f32 v97, v97, v48
  v_add_f32 v98, v98, v48
  v_add_f32 v99, v99, v48
  v_mov_b32 v49, v48
  v_mov_b64 v[50:51], v[48:49]
  v_exp_f32_e32 v96, v96
  v_exp_f32_e32 v97, v97
  v_exp_f32_e32 v98, v98
  v_cvt_pk_bf16_f32 v64, v96, v97
  v_exp_f32_e32 v99, v99
  v_add_f32 v100, v100, v48
  v_cvt_pk_bf16_f32 v65, v98, v99
  v_mfma_f32_16x16x32_bf16 v[96:99], a[64:67], a[0:3], v[48:51]
  ds_read_b128 a[180:183], v33 offset:4096
  ds_read_b128 a[184:187], v34 offset:4096
  ds_read_b128 a[188:191], v35 offset:4096
  v_add_f32 v101, v101, v48
  v_add_f32 v102, v102, v48
  v_add_f32 v103, v103, v48
  v_mfma_f32_16x16x32_bf16 v[96:99], a[68:71], a[4:7], v[96:99]
  s_add_u32 m0, s52, 0x8000
  v_exp_f32_e32 v100, v100
  v_exp_f32_e32 v101, v101
  v_max3_f32 v12, |v240|, |v241|, |v242|
  v_mfma_f32_16x16x32_bf16 v[96:99], a[72:75], a[8:11], v[96:99]
  buffer_load_dwordx4 v16, s[12:15], s42 offen offset:0 sc0 sc1 nt lds
  v_cvt_pk_bf16_f32 v66, v100, v101
  v_exp_f32_e32 v102, v102
  v_exp_f32_e32 v103, v103
  v_mfma_f32_16x16x32_bf16 v[96:99], a[76:79], a[12:15], v[96:99]
  buffer_load_dwordx4 v17, s[12:15], s42 offen offset:1024 sc0 sc1 nt lds
  v_cvt_pk_bf16_f32 v67, v102, v103
  v_max_f32_e64 v12, v12, |v243|
  v_max3_f32 v13, |v244|, |v245|, |v246|
  v_max_f32_e64 v13, v13, |v247|
  s_waitcnt lgkmcnt(15)
  v_max3_f32 v14, |v248|, |v249|, |v250|
  v_mfma_f32_16x16x32_bf16 v[100:103], a[80:83], a[0:3], v[48:51]
  v_max_f32_e64 v14, v14, |v251|
  v_exp_f32_e32 v96, v96
  v_exp_f32_e32 v97, v97
  v_max3_f32 v15, |v252|, |v253|, |v254|
  v_mfma_f32_16x16x32_bf16 v[100:103], a[84:87], a[4:7], v[100:103]
  buffer_load_dwordx4 v18, s[12:15], s42 offen offset:2048 sc0 sc1 nt lds
  v_cvt_pk_bf16_f32 v68, v96, v97
  v_exp_f32_e32 v98, v98
  v_exp_f32_e32 v99, v99
  v_mfma_f32_16x16x32_bf16 v[100:103], a[88:91], a[8:11], v[100:103]
  v_cvt_pk_bf16_f32 v69, v98, v99
  v_max_f32_e64 v15, v15, |v255|
  v_min3_f32 v8, v8, v9, v10
  v_min3_f32 v11, v11, v12, v13
  v_min3_f32 v8, v8, v14, v15
  v_min_f32 v8, v8, v11
  v_mfma_f32_16x16x32_bf16 v[100:103], a[92:95], a[12:15], v[100:103]
  buffer_load_dwordx4 v19, s[12:15], s42 offen offset:3072 sc0 sc1 nt lds
  v_min_f32_dpp v8, v8, v8 row_ror:8 row_mask:0xf bank_mask:0xf
  s_nop 5
  v_exp_f32_e32 v100, v100
  v_exp_f32_e32 v101, v101
  v_min_f32_dpp v8, v8, v8 row_ror:4 row_mask:0xf bank_mask:0xf
  v_cvt_pk_bf16_f32 v70, v100, v101
  v_exp_f32_e32 v102, v102
  v_min_f32_dpp v8, v8, v8 row_ror:2 row_mask:0xf bank_mask:0xf
  v_exp_f32_e32 v103, v103
  s_nop 0
  v_cvt_pk_bf16_f32 v71, v102, v103
  s_nop 1
  v_smfmac_f32_16x16x64_bf16 a[128:131], a[144:147], v[64:71], v29
  v_min_f32_dpp v8, v8, v8 row_ror:1 row_mask:0xf bank_mask:0xf
  v_mov_b32 v9, v8
  s_nop 1
  v_permlane16_swap_b32 v8, v9
  v_min_f32 v8, v8, v9
  v_mov_b32 v9, v8
  s_nop 1
  v_permlane32_swap_b32 v8, v9
  v_min_f32 v8, v8, v9
  v_mul_f32 v8, 0x41800000, v8
  v_mov_b32 v9, v8
  v_mov_b64 v[10:11], v[8:9]
  s_nop 1
  v_mfma_f32_16x16x32_bf16 v[128:131], v[224:227], v[64:67], v[8:11]
  v_mov_b32 v3, v8
  v_mfma_f32_16x16x32_bf16 v[128:131], a[192:195], v[68:71], v[128:131]
  v_mfma_f32_16x16x32_bf16 v[132:135], v[228:231], v[64:67], v[8:11]
  v_mfma_f32_16x16x32_bf16 v[132:135], a[196:199], v[68:71], v[132:135]
  v_mfma_f32_16x16x32_bf16 v[136:139], v[232:235], v[64:67], v[8:11]
  v_mfma_f32_16x16x32_bf16 v[136:139], a[200:203], v[68:71], v[136:139]
  v_mfma_f32_16x16x32_bf16 v[140:143], v[236:239], v[64:67], v[8:11]
  v_mfma_f32_16x16x32_bf16 v[140:143], a[204:207], v[68:71], v[140:143]
  v_mfma_f32_16x16x32_bf16 v[144:147], v[240:243], v[64:67], v[8:11]
  s_waitcnt vmcnt(12)
  ds_read_b128 a[16:19], v20 offset:16384
  s_waitcnt lgkmcnt(15)
  v_mfma_f32_16x16x32_bf16 v[144:147], a[208:211], v[68:71], v[144:147]
  ds_read_b128 a[20:23], v21 offset:16384
  ds_read_b128 a[24:27], v22 offset:16384
  v_mfma_f32_16x16x32_bf16 v[148:151], v[244:247], v[64:67], v[8:11]
  ds_read_b128 a[28:31], v23 offset:16384
  s_waitcnt lgkmcnt(15)
  v_mfma_f32_16x16x32_bf16 v[148:151], a[212:215], v[68:71], v[148:151]
  v_mfma_f32_16x16x32_bf16 v[152:155], v[248:251], v[64:67], v[8:11]
  s_waitcnt lgkmcnt(14)
  v_mfma_f32_16x16x32_bf16 v[152:155], a[216:219], v[68:71], v[152:155]
  v_mfma_f32_16x16x32_bf16 v[156:159], v[252:255], v[64:67], v[8:11]
  s_waitcnt lgkmcnt(12)
  v_mfma_f32_16x16x32_bf16 v[156:159], a[220:223], v[68:71], v[156:159]
  s_waitcnt lgkmcnt(3)
  v_mfma_f32_16x16x32_bf16 v[160:163], a[150:153], a[16:19], 0
  v_mfma_f32_16x16x32_bf16 v[164:167], a[148:151], a[16:19], 0
  v_mfma_f32_16x16x32_bf16 v[160:163], a[156:159], a[16:19], v[160:163]
  v_mfma_f32_16x16x32_bf16 v[164:167], a[154:157], a[16:19], v[164:167]
  s_waitcnt lgkmcnt(2)
  v_mfma_f32_16x16x32_bf16 v[168:171], a[150:153], a[20:23], 0
  v_mfma_f32_16x16x32_bf16 v[172:175], a[148:151], a[20:23], 0
  v_mfma_f32_16x16x32_bf16 v[168:171], a[156:159], a[20:23], v[168:171]
  v_mfma_f32_16x16x32_bf16 v[172:175], a[154:157], a[20:23], v[172:175]
  s_waitcnt lgkmcnt(1)
  v_mfma_f32_16x16x32_bf16 v[176:179], a[150:153], a[24:27], 0
  v_mfma_f32_16x16x32_bf16 v[180:183], a[148:151], a[24:27], 0
  v_mfma_f32_16x16x32_bf16 v[176:179], a[156:159], a[24:27], v[176:179]
  v_cvt_pk_bf16_f32 v160, v160, v161
  v_cvt_pk_bf16_f32 v162, v162, v163
  v_cvt_pk_bf16_f32 v164, v164, v165
  v_mfma_f32_16x16x32_bf16 v[180:183], a[154:157], a[24:27], v[180:183]
  v_cvt_pk_bf16_f32 v166, v166, v167
  v_accvgpr_write_b32 a16, v160
  v_accvgpr_write_b32 a17, v162
  s_waitcnt lgkmcnt(0)
  v_mfma_f32_16x16x32_bf16 v[184:187], a[150:153], a[28:31], 0
  v_accvgpr_write_b32 a18, v164
  v_accvgpr_write_b32 a19, v166
  v_cvt_pk_bf16_f32 v168, v168, v169
  v_mfma_f32_16x16x32_bf16 v[188:191], a[148:151], a[28:31], 0
  v_cvt_pk_bf16_f32 v170, v170, v171
  v_cvt_pk_bf16_f32 v172, v172, v173
  v_cvt_pk_bf16_f32 v174, v174, v175
  v_mfma_f32_16x16x32_bf16 v[184:187], a[156:159], a[28:31], v[184:187]
  v_accvgpr_write_b32 a20, v168
  v_accvgpr_write_b32 a21, v170
  v_accvgpr_write_b32 a22, v172
  v_mfma_f32_16x16x32_bf16 v[188:191], a[154:157], a[28:31], v[188:191]
  v_accvgpr_write_b32 a23, v174
  v_cvt_pk_bf16_f32 v176, v176, v177
  v_cvt_pk_bf16_f32 v178, v178, v179
  v_mfma_f32_16x16x32_bf16 v[104:107], a[64:67], a[16:19], 0
  ds_read_b128 a[64:67], v32 offset:8192
  v_cvt_pk_bf16_f32 v180, v180, v181
  v_cvt_pk_bf16_f32 v182, v182, v183
  v_mfma_f32_16x16x32_bf16 v[108:111], a[80:83], a[16:19], 0
  ds_read_b128 a[80:83], v32 offset:12288
  v_accvgpr_write_b32 a24, v176
  v_accvgpr_write_b32 a25, v178
  v_mfma_f32_16x16x32_bf16 v[104:107], a[68:71], a[20:23], v[104:107]
  ds_read_b128 a[68:71], v33 offset:8192
  v_accvgpr_write_b32 a26, v180
  v_accvgpr_write_b32 a27, v182
  v_mfma_f32_16x16x32_bf16 v[108:111], a[84:87], a[20:23], v[108:111]
  ds_read_b128 a[84:87], v33 offset:12288
  v_cvt_pk_bf16_f32 v184, v184, v185
  v_cvt_pk_bf16_f32 v186, v186, v187
  v_mfma_f32_16x16x32_bf16 v[104:107], a[72:75], a[24:27], v[104:107]
  ds_read_b128 a[72:75], v34 offset:8192
  v_cvt_pk_bf16_f32 v188, v188, v189
  v_cvt_pk_bf16_f32 v190, v190, v191
  v_accvgpr_write_b32 a28, v184
  v_mfma_f32_16x16x32_bf16 v[108:111], a[88:91], a[24:27], v[108:111]
  ds_read_b128 a[88:91], v34 offset:12288
  v_accvgpr_write_b32 a29, v186
  v_accvgpr_write_b32 a30, v188
  v_accvgpr_write_b32 a31, v190
  s_nop 1
  v_mfma_f32_16x16x32_bf16 v[104:107], a[76:79], a[28:31], v[104:107]
  ds_read_b128 a[76:79], v35 offset:8192
  v_mfma_f32_16x16x32_bf16 v[108:111], a[92:95], a[28:31], v[108:111]
  ds_read_b128 a[92:95], v35 offset:12288
  v_mfma_f32_16x16x32_bf16 v[96:99], a[160:163], a[0:3], v[48:51]
  v_mfma_f32_16x16x32_bf16 v[96:99], a[164:167], a[4:7], v[96:99]
  s_mov_b32 s46, 0xc000
  s_mov_b32 m0, s30
  v_mfma_f32_16x16x32_bf16 v[96:99], a[168:171], a[8:11], v[96:99]
  buffer_load_dwordx4 v44, s[16:19], s46 offen offset:0 lds
  v_max3_f32 v4, v104, v105, v106
  v_max3_f32 v5, v107, v108, v109
  v_max3_f32 v4, v4, v110, v111
  v_max_f32 v4, v4, v5
  v_mov_b32 v5, v4
  v_mfma_f32_16x16x32_bf16 v[96:99], a[172:175], a[12:15], v[96:99]
  buffer_load_dwordx4 v45, s[16:19], s46 offen offset:1024 lds
  v_permlane32_swap_b32 v4, v5
  v_max_f32 v4, v4, v5
  v_mfma_f32_16x16x32_bf16 v[100:103], a[176:179], a[0:3], v[48:51]
  v_mov_b32 v5, v4
  v_mfma_f32_16x16x32_bf16 v[100:103], a[180:183], a[4:7], v[100:103]
  buffer_load_dwordx4 v46, s[16:19], s46 offen offset:2048 lds
  v_permlane16_swap_b32 v4, v5
  v_max_f32 v4, v4, v5
  v_sub_f32 v52, 0xc0600000, v4
  v_add_f32 v104, v104, v52
  v_mfma_f32_16x16x32_bf16 v[100:103], a[184:187], a[8:11], v[100:103]
  v_add_f32 v105, v105, v52
  v_add_f32 v106, v106, v52
  v_add_f32 v107, v107, v52
  v_mov_b32 v53, v52
  v_mov_b64 v[54:55], v[52:53]
  v_add_f32 v108, v108, v52
  v_mfma_f32_16x16x32_bf16 v[100:103], a[188:191], a[12:15], v[100:103]
  buffer_load_dwordx4 v47, s[16:19], s46 offen offset:3072 lds
  v_exp_f32_e32 v104, v104
  v_add_f32 v109, v109, v52
  v_exp_f32_e32 v105, v105
  v_exp_f32_e32 v106, v106
  v_cvt_pk_bf16_f32 v76, v104, v105
  v_exp_f32_e32 v107, v107
  v_add_f32 v110, v110, v52
  v_cvt_pk_bf16_f32 v77, v106, v107
  v_mfma_f32_16x16x32_bf16 v[104:107], a[160:163], a[16:19], v[52:55]
  v_add_f32 v111, v111, v52
  v_exp_f32_e32 v108, v108
  v_mfma_f32_16x16x32_bf16 v[104:107], a[164:167], a[20:23], v[104:107]
  s_mov_b32 s47, 0x8000
  s_mov_b32 m0, s34
  v_exp_f32_e32 v109, v109
  v_mfma_f32_16x16x32_bf16 v[104:107], a[168:171], a[24:27], v[104:107]
  buffer_load_dwordx4 v30, s[20:23], s47 offen offset:0 lds
  v_cvt_pk_bf16_f32 v78, v108, v109
  v_mfma_f32_16x16x32_bf16 v[104:107], a[172:175], a[28:31], v[104:107]
  buffer_load_dwordx4 v31, s[20:23], s47 offen offset:1024 lds
  v_exp_f32_e32 v110, v110
  v_exp_f32_e32 v111, v111
  v_exp_f32_e32 v96, v96
  v_cvt_pk_bf16_f32 v79, v110, v111
  v_mfma_f32_16x16x32_bf16 v[108:111], a[176:179], a[16:19], v[52:55]
  v_exp_f32_e32 v97, v97
  v_mfma_f32_16x16x32_bf16 v[108:111], a[180:183], a[20:23], v[108:111]
  buffer_load_dwordx4 v30, s[20:23], s47 offen offset:2048 lds
  v_cvt_pk_bf16_f32 v64, v96, v97
  v_mfma_f32_16x16x32_bf16 v[108:111], a[184:187], a[24:27], v[108:111]
  v_exp_f32_e32 v98, v98
  v_mfma_f32_16x16x32_bf16 v[108:111], a[188:191], a[28:31], v[108:111]
  buffer_load_dwordx4 v31, s[20:23], s47 offen offset:3072 lds
  s_waitcnt vmcnt(8)
  ds_read_b128 a[32:35], v20 offset:32768
  ds_read_b128 a[36:39], v21 offset:32768
  ds_read_b128 a[40:43], v22 offset:32768
  ds_read_b128 a[44:47], v23 offset:32768
  v_exp_f32_e32 v99, v99
  v_exp_f32_e32 v100, v100
  v_cvt_pk_bf16_f32 v65, v98, v99
  v_exp_f32_e32 v101, v101
  v_exp_f32_e32 v102, v102
  v_cvt_pk_bf16_f32 v66, v100, v101
  v_exp_f32_e32 v103, v103
  v_exp_f32_e32 v104, v104
  v_cvt_pk_bf16_f32 v67, v102, v103
  v_exp_f32_e32 v105, v105
  v_exp_f32_e32 v106, v106
  v_exp_f32_e32 v107, v107
  v_exp_f32_e32 v108, v108
  v_exp_f32_e32 v109, v109
  v_exp_f32_e32 v110, v110
  s_waitcnt lgkmcnt(3)
  v_mfma_f32_16x16x32_bf16 v[192:195], a[150:153], a[32:35], 0
  v_exp_f32_e32 v111, v111
  v_mfma_f32_16x16x32_bf16 v[196:199], a[148:151], a[32:35], 0
  v_mfma_f32_16x16x32_bf16 v[192:195], a[156:159], a[32:35], v[192:195]
  s_add_u32 m0, s52, 0xc000
  v_mfma_f32_16x16x32_bf16 v[196:199], a[154:157], a[32:35], v[196:199]
  buffer_load_dwordx4 v16, s[12:15], s43 offen offset:0 sc0 sc1 nt lds
  s_waitcnt lgkmcnt(2)
  v_mfma_f32_16x16x32_bf16 v[200:203], a[150:153], a[36:39], 0
  buffer_load_dwordx4 v17, s[12:15], s43 offen offset:1024 sc0 sc1 nt lds
  v_mfma_f32_16x16x32_bf16 v[204:207], a[148:151], a[36:39], 0
  v_mfma_f32_16x16x32_bf16 v[200:203], a[156:159], a[36:39], v[200:203]
  buffer_load_dwordx4 v18, s[12:15], s43 offen offset:2048 sc0 sc1 nt lds
  v_cvt_pk_bf16_f32 v192, v192, v193
  v_mfma_f32_16x16x32_bf16 v[204:207], a[154:157], a[36:39], v[204:207]
  v_cvt_pk_bf16_f32 v194, v194, v195
  v_cvt_pk_bf16_f32 v196, v196, v197
  s_waitcnt lgkmcnt(1)
  v_mfma_f32_16x16x32_bf16 v[208:211], a[150:153], a[40:43], 0
  buffer_load_dwordx4 v19, s[12:15], s43 offen offset:3072 sc0 sc1 nt lds
  v_cvt_pk_bf16_f32 v198, v198, v199
  v_mfma_f32_16x16x32_bf16 v[212:215], a[148:151], a[40:43], 0
  v_accvgpr_write_b32 a32, v192
  v_accvgpr_write_b32 a33, v194
  v_mfma_f32_16x16x32_bf16 v[208:211], a[156:159], a[40:43], v[208:211]
  v_accvgpr_write_b32 a34, v196
  v_accvgpr_write_b32 a35, v198
  v_mfma_f32_16x16x32_bf16 v[212:215], a[154:157], a[40:43], v[212:215]
  v_cvt_pk_bf16_f32 v200, v200, v201
  v_cvt_pk_bf16_f32 v202, v202, v203
  s_waitcnt lgkmcnt(0)
  v_mfma_f32_16x16x32_bf16 v[216:219], a[150:153], a[44:47], 0
  v_cvt_pk_bf16_f32 v204, v204, v205
  v_cvt_pk_bf16_f32 v206, v206, v207
  v_mfma_f32_16x16x32_bf16 v[220:223], a[148:151], a[44:47], 0
  v_accvgpr_write_b32 a36, v200
  v_accvgpr_write_b32 a37, v202
  v_mfma_f32_16x16x32_bf16 v[216:219], a[156:159], a[44:47], v[216:219]
  v_accvgpr_write_b32 a38, v204
  v_accvgpr_write_b32 a39, v206
  v_mfma_f32_16x16x32_bf16 v[220:223], a[154:157], a[44:47], v[220:223]
  v_cvt_pk_bf16_f32 v208, v208, v209
  v_cvt_pk_bf16_f32 v210, v210, v211
  v_smfmac_f32_16x16x64_bf16 a[132:135], a[144:147], v[72:79], v29
  v_cvt_pk_bf16_f32 v212, v212, v213
  v_cvt_pk_bf16_f32 v214, v214, v215
  v_mfma_f32_16x16x32_bf16 v[160:163], a[192:195], v[76:79], v[8:11]
  v_accvgpr_write_b32 a40, v208
  v_accvgpr_write_b32 a41, v210
  v_mfma_f32_16x16x32_bf16 v[164:167], a[196:199], v[76:79], v[8:11]
  v_accvgpr_write_b32 a42, v212
  v_accvgpr_write_b32 a43, v214
  v_mfma_f32_16x16x32_bf16 v[168:171], a[200:203], v[76:79], v[8:11]
  v_cvt_pk_bf16_f32 v216, v216, v217
  v_cvt_pk_bf16_f32 v218, v218, v219
  v_mfma_f32_16x16x32_bf16 v[172:175], a[204:207], v[76:79], v[8:11]
  v_cvt_pk_bf16_f32 v220, v220, v221
  v_cvt_pk_bf16_f32 v222, v222, v223
  v_mfma_f32_16x16x32_bf16 v[176:179], a[208:211], v[76:79], v[8:11]
  v_accvgpr_write_b32 a44, v216
  v_accvgpr_write_b32 a45, v218
  v_mfma_f32_16x16x32_bf16 v[180:183], a[212:215], v[76:79], v[8:11]
  v_accvgpr_write_b32 a46, v220
  v_accvgpr_write_b32 a47, v222
  v_mfma_f32_16x16x32_bf16 v[184:187], a[216:219], v[76:79], v[8:11]
  v_cvt_pk_bf16_f32 v72, v104, v105
  v_cvt_pk_bf16_f32 v73, v106, v107
  v_mfma_f32_16x16x32_bf16 v[188:191], a[220:223], v[76:79], v[8:11]
  v_cvt_pk_bf16_f32 v74, v108, v109
  v_cvt_pk_bf16_f32 v75, v110, v111
  v_mfma_f32_16x16x32_bf16 v[112:115], a[160:163], a[32:35], 0
  v_mfma_f32_16x16x32_bf16 v[116:119], a[176:179], a[32:35], 0
  s_waitcnt lgkmcnt(0)
  s_barrier
  ds_read_b64_tr_b16 a[192:193], v36 offset:24576
  v_mfma_f32_16x16x32_bf16 v[112:115], a[164:167], a[36:39], v[112:115]
  ds_read_b64_tr_b16 a[194:195], v36 offset:28672
  ds_read_b64_tr_b16 a[96:97], v36 offset:16384
  ds_read_b64_tr_b16 a[98:99], v36 offset:20480
  v_mfma_f32_16x16x32_bf16 v[116:119], a[180:183], a[36:39], v[116:119]
  ds_read_b64_tr_b16 a[100:101], v37 offset:16384
  ds_read_b64_tr_b16 a[102:103], v37 offset:20480
  ds_read_b64_tr_b16 a[196:197], v37 offset:24576
  v_mfma_f32_16x16x32_bf16 v[112:115], a[168:171], a[40:43], v[112:115]
  ds_read_b64_tr_b16 a[198:199], v37 offset:28672
  ds_read_b64_tr_b16 a[200:201], v38 offset:24576
  ds_read_b64_tr_b16 a[202:203], v38 offset:28672
  v_mfma_f32_16x16x32_bf16 v[116:119], a[184:187], a[40:43], v[116:119]
  ds_read_b64_tr_b16 a[104:105], v38 offset:16384
  ds_read_b64_tr_b16 a[106:107], v38 offset:20480
  ds_read_b64_tr_b16 a[108:109], v39 offset:16384
  v_mfma_f32_16x16x32_bf16 v[112:115], a[172:175], a[44:47], v[112:115]
  ds_read_b64_tr_b16 a[110:111], v39 offset:20480
  ds_read_b64_tr_b16 a[204:205], v39 offset:24576
  ds_read_b64_tr_b16 a[206:207], v39 offset:28672
  v_mfma_f32_16x16x32_bf16 v[116:119], a[188:191], a[44:47], v[116:119]
  ds_read_b64_tr_b16 a[208:209], v40 offset:24576
  ds_read_b64_tr_b16 a[210:211], v40 offset:28672
  ds_read_b64_tr_b16 a[112:113], v40 offset:16384
  v_mfma_f32_16x16x32_bf16 v[96:99], a[64:67], a[0:3], v[48:51]
  ds_read_b64_tr_b16 a[114:115], v40 offset:20480
  ds_read_b64_tr_b16 a[116:117], v41 offset:16384
  v_max3_f32 v4, v112, v113, v114
  v_mfma_f32_16x16x32_bf16 v[96:99], a[68:71], a[4:7], v[96:99]
  ds_read_b64_tr_b16 a[118:119], v41 offset:20480
  ds_read_b64_tr_b16 a[212:213], v41 offset:24576
  s_mov_b32 s46, 0x10000
  v_mfma_f32_16x16x32_bf16 v[96:99], a[72:75], a[8:11], v[96:99]
  ds_read_b64_tr_b16 a[214:215], v41 offset:28672
  ds_read_b64_tr_b16 a[216:217], v42 offset:24576
  s_mov_b32 m0, s31
  v_mfma_f32_16x16x32_bf16 v[96:99], a[76:79], a[12:15], v[96:99]
  buffer_load_dwordx4 v44, s[16:19], s46 offen offset:0 lds
  buffer_load_dwordx4 v45, s[16:19], s46 offen offset:1024 lds
  v_max3_f32 v5, v115, v116, v117
  v_mfma_f32_16x16x32_bf16 v[100:103], a[80:83], a[0:3], v[48:51]
  ds_read_b64_tr_b16 a[218:219], v42 offset:28672
  ds_read_b64_tr_b16 a[120:121], v42 offset:16384
  v_max3_f32 v4, v4, v118, v119
  v_mfma_f32_16x16x32_bf16 v[100:103], a[84:87], a[4:7], v[100:103]
  buffer_load_dwordx4 v46, s[16:19], s46 offen offset:2048 lds
  ds_read_b64_tr_b16 a[122:123], v42 offset:20480
  v_max_f32 v4, v4, v5
  v_mfma_f32_16x16x32_bf16 v[100:103], a[88:91], a[8:11], v[100:103]
  ds_read_b64_tr_b16 a[124:125], v43 offset:16384
  ds_read_b64_tr_b16 a[126:127], v43 offset:20480
  v_mov_b32 v5, v4
  v_mfma_f32_16x16x32_bf16 v[100:103], a[92:95], a[12:15], v[100:103]
  buffer_load_dwordx4 v47, s[16:19], s46 offen offset:3072 lds
  v_permlane32_swap_b32 v4, v5
  v_mfma_f32_16x16x32_bf16 v[104:107], a[64:67], a[16:19], v[52:55]
  ds_read_b64_tr_b16 a[220:221], v43 offset:24576
  ds_read_b64_tr_b16 a[222:223], v43 offset:28672
  ds_read_b128 a[160:163], v32 offset:16384
  v_max_f32 v4, v4, v5
  v_mfma_f32_16x16x32_bf16 v[104:107], a[68:71], a[20:23], v[104:107]
  ds_read_b128 a[164:167], v33 offset:16384
  ds_read_b128 a[168:171], v34 offset:16384
  ds_read_b128 a[172:175], v35 offset:16384
  v_mov_b32 v5, v4
  v_mfma_f32_16x16x32_bf16 v[104:107], a[72:75], a[24:27], v[104:107]
  ds_read_b128 a[176:179], v32 offset:20480
  ds_read_b128 a[180:183], v33 offset:20480
  v_permlane16_swap_b32 v4, v5
  v_mfma_f32_16x16x32_bf16 v[104:107], a[76:79], a[28:31], v[104:107]
  ds_read_b128 a[184:187], v34 offset:20480
  ds_read_b128 a[188:191], v35 offset:20480
  v_max_f32 v4, v4, v5
  v_sub_f32 v56, 0xc0600000, v4
  v_mfma_f32_16x16x32_bf16 v[108:111], a[80:83], a[16:19], v[52:55]
  v_add_f32 v112, v112, v56
  v_add_f32 v113, v113, v56
  v_add_f32 v114, v114, v56
  v_add_f32 v115, v115, v56
  v_mfma_f32_16x16x32_bf16 v[108:111], a[84:87], a[20:23], v[108:111]
  v_mov_b32 v57, v56
  v_mov_b64 v[58:59], v[56:57]
  v_exp_f32_e32 v112, v112
  v_mfma_f32_16x16x32_bf16 v[108:111], a[88:91], a[24:27], v[108:111]
  v_exp_f32_e32 v113, v113
  v_add_f32 v116, v116, v56
  v_mfma_f32_16x16x32_bf16 v[108:111], a[92:95], a[28:31], v[108:111]
  v_cvt_pk_bf16_f32 v80, v112, v113
  v_exp_f32_e32 v114, v114
  v_exp_f32_e32 v115, v115
  v_add_f32 v117, v117, v56
  v_cvt_pk_bf16_f32 v81, v114, v115
  v_mfma_f32_16x16x32_bf16 v[112:115], a[64:67], a[32:35], v[56:59]
  ds_read_b128 a[64:67], v32 offset:24576
  v_add_f32 v118, v118, v56
  v_add_f32 v119, v119, v56
  v_mfma_f32_16x16x32_bf16 v[112:115], a[68:71], a[36:39], v[112:115]
  ds_read_b128 a[68:71], v33 offset:24576
  v_exp_f32_e32 v116, v116
  v_mfma_f32_16x16x32_bf16 v[112:115], a[72:75], a[40:43], v[112:115]
  ds_read_b128 a[72:75], v34 offset:24576
  v_exp_f32_e32 v117, v117
  v_mfma_f32_16x16x32_bf16 v[112:115], a[76:79], a[44:47], v[112:115]
  ds_read_b128 a[76:79], v35 offset:24576
  v_cvt_pk_bf16_f32 v82, v116, v117
  v_exp_f32_e32 v118, v118
  v_exp_f32_e32 v119, v119
  v_exp_f32_e32 v96, v96
  v_cvt_pk_bf16_f32 v83, v118, v119
  v_mfma_f32_16x16x32_bf16 v[116:119], a[80:83], a[32:35], v[56:59]
  ds_read_b128 a[80:83], v32 offset:28672
  v_exp_f32_e32 v97, v97
  v_exp_f32_e32 v98, v98
  v_cvt_pk_bf16_f32 v68, v96, v97
  v_mfma_f32_16x16x32_bf16 v[116:119], a[84:87], a[36:39], v[116:119]
  ds_read_b128 a[84:87], v33 offset:28672
  v_exp_f32_e32 v99, v99
  v_mfma_f32_16x16x32_bf16 v[116:119], a[88:91], a[40:43], v[116:119]
  ds_read_b128 a[88:91], v34 offset:28672
  v_cvt_pk_bf16_f32 v69, v98, v99
  v_mfma_f32_16x16x32_bf16 v[116:119], a[92:95], a[44:47], v[116:119]
  ds_read_b128 a[92:95], v35 offset:28672
  v_exp_f32_e32 v100, v100
  v_exp_f32_e32 v101, v101
  v_exp_f32_e32 v102, v102
  v_cvt_pk_bf16_f32 v70, v100, v101
  v_exp_f32_e32 v103, v103
  v_exp_f32_e32 v104, v104
  v_cvt_pk_bf16_f32 v71, v102, v103
  s_nop 1
  v_smfmac_f32_16x16x64_bf16 a[128:131], a[144:147], v[64:71], v29
  v_exp_f32_e32 v105, v105
  s_waitcnt lgkmcnt(15)
  v_mfma_f32_16x16x32_bf16 v[128:131], a[192:195], v[68:71], v[128:131]
  v_cvt_pk_bf16_f32 v76, v104, v105
  v_mfma_f32_16x16x32_bf16 v[128:131], a[96:99], v[64:67], v[128:131]
  v_exp_f32_e32 v106, v106
  v_mfma_f32_16x16x32_bf16 v[132:135], a[100:103], v[64:67], v[132:135]
  v_exp_f32_e32 v107, v107
  v_mfma_f32_16x16x32_bf16 v[132:135], a[196:199], v[68:71], v[132:135]
  v_cvt_pk_bf16_f32 v77, v106, v107
  v_mfma_f32_16x16x32_bf16 v[136:139], a[200:203], v[68:71], v[136:139]
  v_exp_f32_e32 v108, v108
  v_mfma_f32_16x16x32_bf16 v[136:139], a[104:107], v[64:67], v[136:139]
  v_exp_f32_e32 v109, v109
  v_mfma_f32_16x16x32_bf16 v[140:143], a[108:111], v[64:67], v[140:143]
  v_cvt_pk_bf16_f32 v78, v108, v109
  v_mfma_f32_16x16x32_bf16 v[140:143], a[204:207], v[68:71], v[140:143]
  v_exp_f32_e32 v110, v110
  v_mfma_f32_16x16x32_bf16 v[144:147], a[208:211], v[68:71], v[144:147]
  v_exp_f32_e32 v111, v111
  v_mfma_f32_16x16x32_bf16 v[144:147], a[112:115], v[64:67], v[144:147]
  v_cvt_pk_bf16_f32 v79, v110, v111
  v_mfma_f32_16x16x32_bf16 v[148:151], a[116:119], v[64:67], v[148:151]
  v_exp_f32_e32 v112, v112
  v_mfma_f32_16x16x32_bf16 v[148:151], a[212:215], v[68:71], v[148:151]
  v_exp_f32_e32 v113, v113
  v_mfma_f32_16x16x32_bf16 v[152:155], a[216:219], v[68:71], v[152:155]
  v_cvt_pk_bf16_f32 v84, v112, v113
  v_mfma_f32_16x16x32_bf16 v[152:155], a[120:123], v[64:67], v[152:155]
  v_exp_f32_e32 v114, v114
  v_mfma_f32_16x16x32_bf16 v[156:159], a[124:127], v[64:67], v[156:159]
  v_exp_f32_e32 v115, v115
  v_mfma_f32_16x16x32_bf16 v[156:159], a[220:223], v[68:71], v[156:159]
  v_cvt_pk_bf16_f32 v85, v114, v115
  v_smfmac_f32_16x16x64_bf16 a[132:135], a[144:147], v[72:79], v29
  v_exp_f32_e32 v116, v116
  v_mfma_f32_16x16x32_bf16 v[160:163], a[192:195], v[76:79], v[160:163]
  v_exp_f32_e32 v117, v117
  v_mfma_f32_16x16x32_bf16 v[160:163], a[96:99], v[72:75], v[160:163]
  v_cvt_pk_bf16_f32 v86, v116, v117
  v_mfma_f32_16x16x32_bf16 v[164:167], a[100:103], v[72:75], v[164:167]
  v_exp_f32_e32 v118, v118
  v_mfma_f32_16x16x32_bf16 v[164:167], a[196:199], v[76:79], v[164:167]
  v_exp_f32_e32 v119, v119
  v_mfma_f32_16x16x32_bf16 v[168:171], a[200:203], v[76:79], v[168:171]
  v_cvt_pk_bf16_f32 v87, v118, v119
  v_mfma_f32_16x16x32_bf16 v[168:171], a[104:107], v[72:75], v[168:171]
  v_mfma_f32_16x16x32_bf16 v[172:175], a[108:111], v[72:75], v[172:175]
  v_mfma_f32_16x16x32_bf16 v[172:175], a[204:207], v[76:79], v[172:175]
  v_mfma_f32_16x16x32_bf16 v[176:179], a[208:211], v[76:79], v[176:179]
  v_mfma_f32_16x16x32_bf16 v[176:179], a[112:115], v[72:75], v[176:179]
  v_mfma_f32_16x16x32_bf16 v[180:183], a[116:119], v[72:75], v[180:183]
  v_mfma_f32_16x16x32_bf16 v[180:183], a[212:215], v[76:79], v[180:183]
  v_mfma_f32_16x16x32_bf16 v[184:187], a[216:219], v[76:79], v[184:187]
  v_mfma_f32_16x16x32_bf16 v[184:187], a[120:123], v[72:75], v[184:187]
  v_mfma_f32_16x16x32_bf16 v[188:191], a[124:127], v[72:75], v[188:191]
  v_mfma_f32_16x16x32_bf16 v[188:191], a[220:223], v[76:79], v[188:191]
  v_mfma_f32_16x16x32_bf16 v[96:99], a[160:163], a[0:3], v[48:51]
  s_waitcnt lgkmcnt(14)
  v_mfma_f32_16x16x32_bf16 v[96:99], a[164:167], a[4:7], v[96:99]
  s_mov_b32 s47, 0xc000
  s_mov_b32 m0, s35
  s_waitcnt lgkmcnt(13)
  v_mfma_f32_16x16x32_bf16 v[96:99], a[168:171], a[8:11], v[96:99]
  buffer_load_dwordx4 v30, s[20:23], s47 offen offset:0 lds
  s_waitcnt lgkmcnt(12)
  v_mfma_f32_16x16x32_bf16 v[96:99], a[172:175], a[12:15], v[96:99]
  buffer_load_dwordx4 v31, s[20:23], s47 offen offset:1024 lds
  s_waitcnt lgkmcnt(11)
  v_mfma_f32_16x16x32_bf16 v[100:103], a[176:179], a[0:3], v[48:51]
  s_waitcnt lgkmcnt(10)
  v_mfma_f32_16x16x32_bf16 v[100:103], a[180:183], a[4:7], v[100:103]
  buffer_load_dwordx4 v30, s[20:23], s47 offen offset:2048 lds
  s_waitcnt lgkmcnt(9)
  v_mfma_f32_16x16x32_bf16 v[100:103], a[184:187], a[8:11], v[100:103]
  s_waitcnt lgkmcnt(8)
  v_mfma_f32_16x16x32_bf16 v[100:103], a[188:191], a[12:15], v[100:103]
  buffer_load_dwordx4 v31, s[20:23], s47 offen offset:3072 lds
  v_mfma_f32_16x16x32_bf16 v[104:107], a[160:163], a[16:19], v[52:55]
  v_exp_f32_e32 v96, v96
  v_mfma_f32_16x16x32_bf16 v[104:107], a[164:167], a[20:23], v[104:107]
  v_exp_f32_e32 v97, v97
  v_mfma_f32_16x16x32_bf16 v[104:107], a[168:171], a[24:27], v[104:107]
  v_cvt_pk_bf16_f32 v64, v96, v97
  v_mfma_f32_16x16x32_bf16 v[104:107], a[172:175], a[28:31], v[104:107]
  v_exp_f32_e32 v98, v98
  v_mfma_f32_16x16x32_bf16 v[108:111], a[176:179], a[16:19], v[52:55]
  v_exp_f32_e32 v99, v99
  v_mfma_f32_16x16x32_bf16 v[108:111], a[180:183], a[20:23], v[108:111]
  v_cvt_pk_bf16_f32 v65, v98, v99
  v_mfma_f32_16x16x32_bf16 v[108:111], a[184:187], a[24:27], v[108:111]
  v_exp_f32_e32 v100, v100
  v_mfma_f32_16x16x32_bf16 v[108:111], a[188:191], a[28:31], v[108:111]
  v_exp_f32_e32 v101, v101
  v_mfma_f32_16x16x32_bf16 v[112:115], a[160:163], a[32:35], v[56:59]
  s_waitcnt vmcnt(8)
  ds_read_b128 a[48:51], v20 offset:49152
  v_mfma_f32_16x16x32_bf16 v[112:115], a[164:167], a[36:39], v[112:115]
  ds_read_b128 a[52:55], v21 offset:49152
  ds_read_b128 a[56:59], v22 offset:49152
  v_mfma_f32_16x16x32_bf16 v[112:115], a[168:171], a[40:43], v[112:115]
  ds_read_b128 a[60:63], v23 offset:49152
  v_cvt_pk_bf16_f32 v66, v100, v101
  v_mfma_f32_16x16x32_bf16 v[112:115], a[172:175], a[44:47], v[112:115]
  v_exp_f32_e32 v102, v102
  v_mfma_f32_16x16x32_bf16 v[116:119], a[176:179], a[32:35], v[56:59]
  v_exp_f32_e32 v103, v103
  v_mfma_f32_16x16x32_bf16 v[116:119], a[180:183], a[36:39], v[116:119]
  v_cvt_pk_bf16_f32 v67, v102, v103
  v_mfma_f32_16x16x32_bf16 v[116:119], a[184:187], a[40:43], v[116:119]
  v_exp_f32_e32 v104, v104
  v_mfma_f32_16x16x32_bf16 v[116:119], a[188:191], a[44:47], v[116:119]
  v_exp_f32_e32 v105, v105
  v_exp_f32_e32 v106, v106
  s_waitcnt lgkmcnt(3)
  v_mfma_f32_16x16x32_bf16 v[224:227], a[150:153], a[48:51], 0
  v_cvt_pk_bf16_f32 v72, v104, v105
  v_mfma_f32_16x16x32_bf16 v[228:231], a[148:151], a[48:51], 0
  v_exp_f32_e32 v107, v107
  v_mfma_f32_16x16x32_bf16 v[224:227], a[156:159], a[48:51], v[224:227]
  v_cvt_pk_bf16_f32 v73, v106, v107
  v_mfma_f32_16x16x32_bf16 v[228:231], a[154:157], a[48:51], v[228:231]
  v_exp_f32_e32 v108, v108
  s_waitcnt lgkmcnt(2)
  v_mfma_f32_16x16x32_bf16 v[232:235], a[150:153], a[52:55], 0
  v_exp_f32_e32 v109, v109
  v_mfma_f32_16x16x32_bf16 v[236:239], a[148:151], a[52:55], 0
  v_cvt_pk_bf16_f32 v74, v108, v109
  v_mfma_f32_16x16x32_bf16 v[232:235], a[156:159], a[52:55], v[232:235]
  v_cvt_pk_bf16_f32 v224, v224, v225
  v_cvt_pk_bf16_f32 v226, v226, v227
  v_mfma_f32_16x16x32_bf16 v[236:239], a[154:157], a[52:55], v[236:239]
  v_cvt_pk_bf16_f32 v228, v228, v229
  v_cvt_pk_bf16_f32 v230, v230, v231
  s_waitcnt lgkmcnt(1)
  v_mfma_f32_16x16x32_bf16 v[240:243], a[150:153], a[56:59], 0
  v_accvgpr_write_b32 a48, v224
  v_accvgpr_write_b32 a49, v226
  v_mfma_f32_16x16x32_bf16 v[244:247], a[148:151], a[56:59], 0
  v_accvgpr_write_b32 a50, v228
  v_accvgpr_write_b32 a51, v230
  v_mfma_f32_16x16x32_bf16 v[240:243], a[156:159], a[56:59], v[240:243]
  v_cvt_pk_bf16_f32 v232, v232, v233
  v_cvt_pk_bf16_f32 v234, v234, v235
  v_mfma_f32_16x16x32_bf16 v[244:247], a[154:157], a[56:59], v[244:247]
  v_cvt_pk_bf16_f32 v236, v236, v237
  v_cvt_pk_bf16_f32 v238, v238, v239
  s_waitcnt lgkmcnt(0)
  v_mfma_f32_16x16x32_bf16 v[248:251], a[150:153], a[60:63], 0
  v_accvgpr_write_b32 a52, v232
  v_accvgpr_write_b32 a53, v234
  v_mfma_f32_16x16x32_bf16 v[252:255], a[148:151], a[60:63], 0
  v_accvgpr_write_b32 a54, v236
  v_accvgpr_write_b32 a55, v238
  v_mfma_f32_16x16x32_bf16 v[248:251], a[156:159], a[60:63], v[248:251]
  v_cvt_pk_bf16_f32 v240, v240, v241
  v_cvt_pk_bf16_f32 v242, v242, v243
  v_mfma_f32_16x16x32_bf16 v[252:255], a[154:157], a[60:63], v[252:255]
  v_cvt_pk_bf16_f32 v244, v244, v245
  v_cvt_pk_bf16_f32 v246, v246, v247
  v_smfmac_f32_16x16x64_bf16 a[136:139], a[144:147], v[80:87], v29
  v_accvgpr_write_b32 a56, v240
  v_accvgpr_write_b32 a57, v242
  v_mfma_f32_16x16x32_bf16 v[192:195], a[96:99], v[80:83], v[8:11]
  v_accvgpr_write_b32 a58, v244
  v_accvgpr_write_b32 a59, v246
  v_mfma_f32_16x16x32_bf16 v[192:195], a[192:195], v[84:87], v[192:195]
  v_cvt_pk_bf16_f32 v248, v248, v249
  v_cvt_pk_bf16_f32 v250, v250, v251
  v_mfma_f32_16x16x32_bf16 v[196:199], a[100:103], v[80:83], v[8:11]
  v_cvt_pk_bf16_f32 v252, v252, v253
  v_cvt_pk_bf16_f32 v254, v254, v255
  v_mfma_f32_16x16x32_bf16 v[196:199], a[196:199], v[84:87], v[196:199]
  v_accvgpr_write_b32 a60, v248
  v_accvgpr_write_b32 a61, v250
  v_mfma_f32_16x16x32_bf16 v[200:203], a[104:107], v[80:83], v[8:11]
  v_accvgpr_write_b32 a62, v252
  v_accvgpr_write_b32 a63, v254
  v_mfma_f32_16x16x32_bf16 v[200:203], a[200:203], v[84:87], v[200:203]
  v_exp_f32_e32 v110, v110
  v_mfma_f32_16x16x32_bf16 v[204:207], a[108:111], v[80:83], v[8:11]
  v_exp_f32_e32 v111, v111
  v_mfma_f32_16x16x32_bf16 v[204:207], a[204:207], v[84:87], v[204:207]
  v_cvt_pk_bf16_f32 v75, v110, v111
  v_mfma_f32_16x16x32_bf16 v[208:211], a[112:115], v[80:83], v[8:11]
  v_exp_f32_e32 v112, v112
  v_mfma_f32_16x16x32_bf16 v[208:211], a[208:211], v[84:87], v[208:211]
  v_exp_f32_e32 v113, v113
  v_mfma_f32_16x16x32_bf16 v[212:215], a[116:119], v[80:83], v[8:11]
  v_exp_f32_e32 v114, v114
  v_mfma_f32_16x16x32_bf16 v[212:215], a[212:215], v[84:87], v[212:215]
  v_exp_f32_e32 v115, v115
  v_mfma_f32_16x16x32_bf16 v[216:219], a[120:123], v[80:83], v[8:11]
  v_exp_f32_e32 v116, v116
  v_mfma_f32_16x16x32_bf16 v[216:219], a[216:219], v[84:87], v[216:219]
  v_exp_f32_e32 v117, v117
  v_mfma_f32_16x16x32_bf16 v[220:223], a[124:127], v[80:83], v[8:11]
  v_cvt_pk_bf16_f32 v80, v112, v113
  v_cvt_pk_bf16_f32 v81, v114, v115
  v_mfma_f32_16x16x32_bf16 v[220:223], a[220:223], v[84:87], v[220:223]
  v_cvt_pk_bf16_f32 v82, v116, v117
  v_mfma_f32_16x16x32_bf16 v[120:123], a[160:163], a[48:51], 0
  v_exp_f32_e32 v118, v118
  v_mfma_f32_16x16x32_bf16 v[124:127], a[176:179], a[48:51], 0
  s_waitcnt lgkmcnt(0)
  s_barrier
  v_mfma_f32_16x16x32_bf16 v[120:123], a[164:167], a[52:55], v[120:123]
  v_exp_f32_e32 v119, v119
  v_mfma_f32_16x16x32_bf16 v[124:127], a[180:183], a[52:55], v[124:127]
  ds_read_b64_tr_b16 a[192:193], v36 offset:40960
  v_cvt_pk_bf16_f32 v83, v118, v119
  v_mfma_f32_16x16x32_bf16 v[120:123], a[168:171], a[56:59], v[120:123]
  ds_read_b64_tr_b16 a[194:195], v36 offset:45056
  ds_read_b64_tr_b16 a[96:97], v36 offset:32768
  v_mfma_f32_16x16x32_bf16 v[124:127], a[184:187], a[56:59], v[124:127]
  ds_read_b64_tr_b16 a[98:99], v36 offset:36864
  ds_read_b64_tr_b16 a[100:101], v37 offset:32768
  v_mfma_f32_16x16x32_bf16 v[120:123], a[172:175], a[60:63], v[120:123]
  ds_read_b64_tr_b16 a[102:103], v37 offset:36864
  ds_read_b64_tr_b16 a[196:197], v37 offset:40960
  v_mfma_f32_16x16x32_bf16 v[124:127], a[188:191], a[60:63], v[124:127]
  ds_read_b64_tr_b16 a[198:199], v37 offset:45056
  ds_read_b64_tr_b16 a[200:201], v38 offset:40960
  v_mfma_f32_16x16x32_bf16 v[96:99], a[64:67], a[0:3], v[48:51]
  ds_read_b64_tr_b16 a[202:203], v38 offset:45056
  ds_read_b64_tr_b16 a[104:105], v38 offset:32768
  v_max3_f32 v4, v120, v121, v122
  v_mfma_f32_16x16x32_bf16 v[96:99], a[68:71], a[4:7], v[96:99]
  ds_read_b64_tr_b16 a[106:107], v38 offset:36864
  ds_read_b64_tr_b16 a[108:109], v39 offset:32768
  s_mov_b32 s46, 0x14000
  v_mfma_f32_16x16x32_bf16 v[96:99], a[72:75], a[8:11], v[96:99]
  ds_read_b64_tr_b16 a[110:111], v39 offset:36864
  ds_read_b64_tr_b16 a[204:205], v39 offset:40960
  s_mov_b32 m0, s28
  v_mfma_f32_16x16x32_bf16 v[96:99], a[76:79], a[12:15], v[96:99]
  buffer_load_dwordx4 v44, s[16:19], s46 offen offset:0 lds
  buffer_load_dwordx4 v45, s[16:19], s46 offen offset:1024 lds
  v_max3_f32 v5, v123, v124, v125
  v_mfma_f32_16x16x32_bf16 v[100:103], a[80:83], a[0:3], v[48:51]
  ds_read_b64_tr_b16 a[206:207], v39 offset:45056
  ds_read_b64_tr_b16 a[208:209], v40 offset:40960
  v_max3_f32 v4, v4, v126, v127
  v_mfma_f32_16x16x32_bf16 v[100:103], a[84:87], a[4:7], v[100:103]
  buffer_load_dwordx4 v46, s[16:19], s46 offen offset:2048 lds
  ds_read_b64_tr_b16 a[210:211], v40 offset:45056
  v_max_f32 v4, v4, v5
  v_mfma_f32_16x16x32_bf16 v[100:103], a[88:91], a[8:11], v[100:103]
  ds_read_b64_tr_b16 a[112:113], v40 offset:32768
  ds_read_b64_tr_b16 a[114:115], v40 offset:36864
  v_mov_b32 v5, v4
  v_mfma_f32_16x16x32_bf16 v[100:103], a[92:95], a[12:15], v[100:103]
  buffer_load_dwordx4 v47, s[16:19], s46 offen offset:3072 lds
  v_permlane32_swap_b32 v4, v5
  v_mfma_f32_16x16x32_bf16 v[104:107], a[64:67], a[16:19], v[52:55]
  ds_read_b64_tr_b16 a[116:117], v41 offset:32768
  v_max_f32 v4, v4, v5
  v_mfma_f32_16x16x32_bf16 v[104:107], a[68:71], a[20:23], v[104:107]
  ds_read_b64_tr_b16 a[118:119], v41 offset:36864
  v_mov_b32 v5, v4
  v_mfma_f32_16x16x32_bf16 v[104:107], a[72:75], a[24:27], v[104:107]
  v_exp_f32_e32 v96, v96
  v_mfma_f32_16x16x32_bf16 v[104:107], a[76:79], a[28:31], v[104:107]
  v_permlane16_swap_b32 v4, v5
  v_mfma_f32_16x16x32_bf16 v[108:111], a[80:83], a[16:19], v[52:55]
  ds_read_b64_tr_b16 a[212:213], v41 offset:40960
  v_max_f32 v4, v4, v5
  v_mfma_f32_16x16x32_bf16 v[108:111], a[84:87], a[20:23], v[108:111]
  ds_read_b64_tr_b16 a[214:215], v41 offset:45056
  v_sub_f32 v60, 0xc0600000, v4
  v_mfma_f32_16x16x32_bf16 v[108:111], a[88:91], a[24:27], v[108:111]
  ds_read_b64_tr_b16 a[216:217], v42 offset:40960
  v_add_f32 v120, v120, v60
  v_mfma_f32_16x16x32_bf16 v[108:111], a[92:95], a[28:31], v[108:111]
  ds_read_b64_tr_b16 a[218:219], v42 offset:45056
  v_add_f32 v121, v121, v60
  v_mfma_f32_16x16x32_bf16 v[112:115], a[64:67], a[32:35], v[56:59]
  ds_read_b64_tr_b16 a[120:121], v42 offset:32768
  ds_read_b64_tr_b16 a[122:123], v42 offset:36864
  v_add_f32 v122, v122, v60
  v_mfma_f32_16x16x32_bf16 v[112:115], a[68:71], a[36:39], v[112:115]
  ds_read_b64_tr_b16 a[124:125], v43 offset:32768
  ds_read_b64_tr_b16 a[126:127], v43 offset:36864
  v_add_f32 v123, v123, v60
  v_mfma_f32_16x16x32_bf16 v[112:115], a[72:75], a[40:43], v[112:115]
  ds_read_b64_tr_b16 a[220:221], v43 offset:40960
  ds_read_b64_tr_b16 a[222:223], v43 offset:45056
  v_mov_b32 v61, v60
  v_mfma_f32_16x16x32_bf16 v[112:115], a[76:79], a[44:47], v[112:115]
  ds_read_b128 a[160:163], v32 offset:32768
  ds_read_b128 a[164:167], v33 offset:32768
  v_mov_b64 v[62:63], v[60:61]
  v_mfma_f32_16x16x32_bf16 v[116:119], a[80:83], a[32:35], v[56:59]
  ds_read_b128 a[168:171], v34 offset:32768
  v_exp_f32_e32 v120, v120
  v_mfma_f32_16x16x32_bf16 v[116:119], a[84:87], a[36:39], v[116:119]
  ds_read_b128 a[172:175], v35 offset:32768
  v_exp_f32_e32 v121, v121
  v_mfma_f32_16x16x32_bf16 v[116:119], a[88:91], a[40:43], v[116:119]
  ds_read_b128 a[176:179], v32 offset:36864
  ds_read_b128 a[180:183], v33 offset:36864
  v_cvt_pk_bf16_f32 v88, v120, v121
  v_mfma_f32_16x16x32_bf16 v[116:119], a[92:95], a[44:47], v[116:119]
  ds_read_b128 a[184:187], v34 offset:36864
  v_exp_f32_e32 v122, v122
  v_exp_f32_e32 v123, v123
  v_add_f32 v124, v124, v60
  v_cvt_pk_bf16_f32 v89, v122, v123
  v_mfma_f32_16x16x32_bf16 v[120:123], a[64:67], a[48:51], v[60:63]
  ds_read_b128 a[188:191], v35 offset:36864
  ds_read_b128 a[64:67], v32 offset:40960
  v_add_f32 v125, v125, v60
  v_add_f32 v126, v126, v60
  v_mfma_f32_16x16x32_bf16 v[120:123], a[68:71], a[52:55], v[120:123]
  ds_read_b128 a[68:71], v33 offset:40960
  v_add_f32 v127, v127, v60
  v_exp_f32_e32 v124, v124
  v_mfma_f32_16x16x32_bf16 v[120:123], a[72:75], a[56:59], v[120:123]
  ds_read_b128 a[72:75], v34 offset:40960
  v_exp_f32_e32 v125, v125
  v_lshlrev_b32 v20, 2, v0
  v_mfma_f32_16x16x32_bf16 v[120:123], a[76:79], a[60:63], v[120:123]
  ds_read_b128 a[76:79], v35 offset:40960
  v_cvt_pk_bf16_f32 v90, v124, v125
  v_add_u32 v20, 0x21a00, v20
  v_exp_f32_e32 v126, v126
  v_exp_f32_e32 v127, v127
  v_exp_f32_e32 v97, v97
  v_cvt_pk_bf16_f32 v91, v126, v127
  v_mfma_f32_16x16x32_bf16 v[124:127], a[80:83], a[48:51], v[60:63]
  ds_read_b128 a[80:83], v32 offset:45056
  v_cvt_pk_bf16_f32 v68, v96, v97
  v_exp_f32_e32 v98, v98
  v_mfma_f32_16x16x32_bf16 v[124:127], a[84:87], a[52:55], v[124:127]
  ds_read_b128 a[84:87], v33 offset:45056
  v_exp_f32_e32 v99, v99
  v_lshlrev_b32 v21, 8, v2
  v_mfma_f32_16x16x32_bf16 v[124:127], a[88:91], a[56:59], v[124:127]
  ds_read_b128 a[88:91], v34 offset:45056
  v_cvt_pk_bf16_f32 v69, v98, v99
  v_add_u32 v21, 0x21a00, v21
  v_mfma_f32_16x16x32_bf16 v[124:127], a[92:95], a[60:63], v[124:127]
  ds_read_b128 a[92:95], v35 offset:45056
  v_exp_f32_e32 v100, v100
  v_exp_f32_e32 v101, v101
  v_exp_f32_e32 v102, v102
  v_cvt_pk_bf16_f32 v70, v100, v101
  v_exp_f32_e32 v103, v103
  v_exp_f32_e32 v104, v104
  v_cvt_pk_bf16_f32 v71, v102, v103
  s_nop 1
  v_smfmac_f32_16x16x64_bf16 a[128:131], a[144:147], v[64:71], v29
  v_exp_f32_e32 v105, v105
  s_waitcnt lgkmcnt(15)
  v_mfma_f32_16x16x32_bf16 v[128:131], a[192:195], v[68:71], v[128:131]
  v_cvt_pk_bf16_f32 v76, v104, v105
  v_mov_b32 v22, 0
  v_mfma_f32_16x16x32_bf16 v[128:131], a[96:99], v[64:67], v[128:131]
  v_exp_f32_e32 v106, v106
  v_mfma_f32_16x16x32_bf16 v[132:135], a[100:103], v[64:67], v[132:135]
  v_exp_f32_e32 v107, v107
  v_mfma_f32_16x16x32_bf16 v[132:135], a[196:199], v[68:71], v[132:135]
  v_cvt_pk_bf16_f32 v77, v106, v107
  v_mfma_f32_16x16x32_bf16 v[136:139], a[200:203], v[68:71], v[136:139]
  v_exp_f32_e32 v108, v108
  v_mfma_f32_16x16x32_bf16 v[136:139], a[104:107], v[64:67], v[136:139]
  v_exp_f32_e32 v109, v109
  v_mfma_f32_16x16x32_bf16 v[140:143], a[108:111], v[64:67], v[140:143]
  v_cvt_pk_bf16_f32 v78, v108, v109
  v_mfma_f32_16x16x32_bf16 v[140:143], a[204:207], v[68:71], v[140:143]
  v_exp_f32_e32 v110, v110
  v_mfma_f32_16x16x32_bf16 v[144:147], a[208:211], v[68:71], v[144:147]
  v_exp_f32_e32 v111, v111
  v_mfma_f32_16x16x32_bf16 v[144:147], a[112:115], v[64:67], v[144:147]
  v_cvt_pk_bf16_f32 v79, v110, v111
  v_mfma_f32_16x16x32_bf16 v[148:151], a[116:119], v[64:67], v[148:151]
  v_exp_f32_e32 v112, v112
  v_mfma_f32_16x16x32_bf16 v[148:151], a[212:215], v[68:71], v[148:151]
  v_exp_f32_e32 v113, v113
  v_mfma_f32_16x16x32_bf16 v[152:155], a[216:219], v[68:71], v[152:155]
  v_cvt_pk_bf16_f32 v84, v112, v113
  v_mfma_f32_16x16x32_bf16 v[152:155], a[120:123], v[64:67], v[152:155]
  v_exp_f32_e32 v114, v114
  v_mfma_f32_16x16x32_bf16 v[156:159], a[124:127], v[64:67], v[156:159]
  v_exp_f32_e32 v115, v115
  v_mfma_f32_16x16x32_bf16 v[156:159], a[220:223], v[68:71], v[156:159]
  v_cvt_pk_bf16_f32 v85, v114, v115
  v_smfmac_f32_16x16x64_bf16 a[132:135], a[144:147], v[72:79], v29
  v_exp_f32_e32 v116, v116
  v_mfma_f32_16x16x32_bf16 v[160:163], a[192:195], v[76:79], v[160:163]
  v_exp_f32_e32 v117, v117
  v_mfma_f32_16x16x32_bf16 v[160:163], a[96:99], v[72:75], v[160:163]
  v_cvt_pk_bf16_f32 v86, v116, v117
  v_mfma_f32_16x16x32_bf16 v[164:167], a[100:103], v[72:75], v[164:167]
  v_exp_f32_e32 v118, v118
  v_mfma_f32_16x16x32_bf16 v[164:167], a[196:199], v[76:79], v[164:167]
  v_exp_f32_e32 v119, v119
  v_mfma_f32_16x16x32_bf16 v[168:171], a[200:203], v[76:79], v[168:171]
  v_cvt_pk_bf16_f32 v87, v118, v119
  v_mfma_f32_16x16x32_bf16 v[168:171], a[104:107], v[72:75], v[168:171]
  v_exp_f32_e32 v120, v120
  v_mfma_f32_16x16x32_bf16 v[172:175], a[108:111], v[72:75], v[172:175]
  v_exp_f32_e32 v121, v121
  v_mfma_f32_16x16x32_bf16 v[172:175], a[204:207], v[76:79], v[172:175]
  v_cvt_pk_bf16_f32 v92, v120, v121
  v_mfma_f32_16x16x32_bf16 v[176:179], a[208:211], v[76:79], v[176:179]
  v_exp_f32_e32 v122, v122
  v_mfma_f32_16x16x32_bf16 v[176:179], a[112:115], v[72:75], v[176:179]
  v_exp_f32_e32 v123, v123
  v_mfma_f32_16x16x32_bf16 v[180:183], a[116:119], v[72:75], v[180:183]
  v_cvt_pk_bf16_f32 v93, v122, v123
  v_mfma_f32_16x16x32_bf16 v[180:183], a[212:215], v[76:79], v[180:183]
  v_exp_f32_e32 v124, v124
  v_mfma_f32_16x16x32_bf16 v[184:187], a[216:219], v[76:79], v[184:187]
  v_exp_f32_e32 v125, v125
  v_mfma_f32_16x16x32_bf16 v[184:187], a[120:123], v[72:75], v[184:187]
  v_cvt_pk_bf16_f32 v94, v124, v125
  v_mfma_f32_16x16x32_bf16 v[188:191], a[124:127], v[72:75], v[188:191]
  v_exp_f32_e32 v126, v126
  v_mfma_f32_16x16x32_bf16 v[188:191], a[220:223], v[76:79], v[188:191]
  v_exp_f32_e32 v127, v127
  v_mfma_f32_16x16x32_bf16 v[96:99], a[160:163], a[0:3], v[48:51]
  v_cvt_pk_bf16_f32 v95, v126, v127
  s_waitcnt lgkmcnt(14)
  v_mfma_f32_16x16x32_bf16 v[96:99], a[164:167], a[4:7], v[96:99]
  s_mov_b32 s47, 0x10000
  s_mov_b32 m0, s32
  s_waitcnt lgkmcnt(13)
  v_mfma_f32_16x16x32_bf16 v[96:99], a[168:171], a[8:11], v[96:99]
  buffer_load_dwordx4 v30, s[20:23], s47 offen offset:0 lds
  s_waitcnt lgkmcnt(12)
  v_mfma_f32_16x16x32_bf16 v[96:99], a[172:175], a[12:15], v[96:99]
  buffer_load_dwordx4 v31, s[20:23], s47 offen offset:1024 lds
  s_waitcnt lgkmcnt(11)
  v_mfma_f32_16x16x32_bf16 v[100:103], a[176:179], a[0:3], v[48:51]
  ds_write_b32 v20, v22
  s_waitcnt lgkmcnt(11)
  v_mfma_f32_16x16x32_bf16 v[100:103], a[180:183], a[4:7], v[100:103]
  buffer_load_dwordx4 v30, s[20:23], s47 offen offset:2048 lds
  s_waitcnt lgkmcnt(10)
  v_mfma_f32_16x16x32_bf16 v[100:103], a[184:187], a[8:11], v[100:103]
  s_waitcnt lgkmcnt(9)
  v_mfma_f32_16x16x32_bf16 v[100:103], a[188:191], a[12:15], v[100:103]
  buffer_load_dwordx4 v31, s[20:23], s47 offen offset:3072 lds
  v_mfma_f32_16x16x32_bf16 v[104:107], a[160:163], a[16:19], v[52:55]
  v_exp_f32_e32 v96, v96
  v_mfma_f32_16x16x32_bf16 v[104:107], a[164:167], a[20:23], v[104:107]
  v_exp_f32_e32 v97, v97
  v_mfma_f32_16x16x32_bf16 v[104:107], a[168:171], a[24:27], v[104:107]
  v_cvt_pk_bf16_f32 v64, v96, v97
  v_mfma_f32_16x16x32_bf16 v[104:107], a[172:175], a[28:31], v[104:107]
  v_exp_f32_e32 v98, v98
  v_mfma_f32_16x16x32_bf16 v[108:111], a[176:179], a[16:19], v[52:55]
  v_exp_f32_e32 v99, v99
  v_mfma_f32_16x16x32_bf16 v[108:111], a[180:183], a[20:23], v[108:111]
  v_cvt_pk_bf16_f32 v65, v98, v99
  v_mfma_f32_16x16x32_bf16 v[108:111], a[184:187], a[24:27], v[108:111]
  v_exp_f32_e32 v100, v100
  v_mfma_f32_16x16x32_bf16 v[108:111], a[188:191], a[28:31], v[108:111]
  v_exp_f32_e32 v101, v101
  v_mfma_f32_16x16x32_bf16 v[112:115], a[160:163], a[32:35], v[56:59]
  v_cvt_pk_bf16_f32 v66, v100, v101
  v_mfma_f32_16x16x32_bf16 v[112:115], a[164:167], a[36:39], v[112:115]
  v_exp_f32_e32 v102, v102
  v_mfma_f32_16x16x32_bf16 v[112:115], a[168:171], a[40:43], v[112:115]
  v_exp_f32_e32 v103, v103
  v_mfma_f32_16x16x32_bf16 v[112:115], a[172:175], a[44:47], v[112:115]
  v_cvt_pk_bf16_f32 v67, v102, v103
  v_mfma_f32_16x16x32_bf16 v[116:119], a[176:179], a[32:35], v[56:59]
  v_exp_f32_e32 v104, v104
  v_mfma_f32_16x16x32_bf16 v[116:119], a[180:183], a[36:39], v[116:119]
  v_exp_f32_e32 v105, v105
  v_mfma_f32_16x16x32_bf16 v[116:119], a[184:187], a[40:43], v[116:119]
  v_cvt_pk_bf16_f32 v72, v104, v105
  v_mfma_f32_16x16x32_bf16 v[116:119], a[188:191], a[44:47], v[116:119]
  v_exp_f32_e32 v106, v106
  v_mfma_f32_16x16x32_bf16 v[120:123], a[160:163], a[48:51], v[60:63]
  v_exp_f32_e32 v107, v107
  v_mfma_f32_16x16x32_bf16 v[120:123], a[164:167], a[52:55], v[120:123]
  v_cvt_pk_bf16_f32 v73, v106, v107
  v_mfma_f32_16x16x32_bf16 v[120:123], a[168:171], a[56:59], v[120:123]
  v_exp_f32_e32 v108, v108
  v_mfma_f32_16x16x32_bf16 v[120:123], a[172:175], a[60:63], v[120:123]
  v_exp_f32_e32 v109, v109
  v_mfma_f32_16x16x32_bf16 v[124:127], a[176:179], a[48:51], v[60:63]
  v_cvt_pk_bf16_f32 v74, v108, v109
  v_mfma_f32_16x16x32_bf16 v[124:127], a[180:183], a[52:55], v[124:127]
  v_exp_f32_e32 v110, v110
  v_mfma_f32_16x16x32_bf16 v[124:127], a[184:187], a[56:59], v[124:127]
  v_exp_f32_e32 v111, v111
  v_mfma_f32_16x16x32_bf16 v[124:127], a[188:191], a[60:63], v[124:127]
  v_cvt_pk_bf16_f32 v75, v110, v111
  v_smfmac_f32_16x16x64_bf16 a[136:139], a[144:147], v[80:87], v29
  v_exp_f32_e32 v112, v112
  v_mfma_f32_16x16x32_bf16 v[192:195], a[192:195], v[84:87], v[192:195]
  v_exp_f32_e32 v113, v113
  v_mfma_f32_16x16x32_bf16 v[192:195], a[96:99], v[80:83], v[192:195]
  v_exp_f32_e32 v114, v114
  v_mfma_f32_16x16x32_bf16 v[196:199], a[100:103], v[80:83], v[196:199]
  v_exp_f32_e32 v115, v115
  v_mfma_f32_16x16x32_bf16 v[196:199], a[196:199], v[84:87], v[196:199]
  v_exp_f32_e32 v116, v116
  v_mfma_f32_16x16x32_bf16 v[200:203], a[200:203], v[84:87], v[200:203]
  v_exp_f32_e32 v117, v117
  v_mfma_f32_16x16x32_bf16 v[200:203], a[104:107], v[80:83], v[200:203]
  v_exp_f32_e32 v118, v118
  v_mfma_f32_16x16x32_bf16 v[204:207], a[108:111], v[80:83], v[204:207]
  v_exp_f32_e32 v119, v119
  v_mfma_f32_16x16x32_bf16 v[204:207], a[204:207], v[84:87], v[204:207]
  v_exp_f32_e32 v120, v120
  v_mfma_f32_16x16x32_bf16 v[208:211], a[208:211], v[84:87], v[208:211]
  v_exp_f32_e32 v121, v121
  v_mfma_f32_16x16x32_bf16 v[208:211], a[112:115], v[80:83], v[208:211]
  v_exp_f32_e32 v122, v122
  v_mfma_f32_16x16x32_bf16 v[212:215], a[116:119], v[80:83], v[212:215]
  v_mfma_f32_16x16x32_bf16 v[212:215], a[212:215], v[84:87], v[212:215]
  v_mfma_f32_16x16x32_bf16 v[216:219], a[216:219], v[84:87], v[216:219]
  v_mfma_f32_16x16x32_bf16 v[216:219], a[120:123], v[80:83], v[216:219]
  v_mfma_f32_16x16x32_bf16 v[220:223], a[124:127], v[80:83], v[220:223]
  v_cvt_pk_bf16_f32 v80, v112, v113
  v_cvt_pk_bf16_f32 v81, v114, v115
  v_mfma_f32_16x16x32_bf16 v[220:223], a[220:223], v[84:87], v[220:223]
  v_cvt_pk_bf16_f32 v82, v116, v117
  v_cvt_pk_bf16_f32 v83, v118, v119
  v_smfmac_f32_16x16x64_bf16 a[140:143], a[144:147], v[88:95], v29
  v_mfma_f32_16x16x32_bf16 v[224:227], a[96:99], v[88:91], v[8:11]
  v_mfma_f32_16x16x32_bf16 v[224:227], a[192:195], v[92:95], v[224:227]
  v_mfma_f32_16x16x32_bf16 v[228:231], a[100:103], v[88:91], v[8:11]
  v_mfma_f32_16x16x32_bf16 v[228:231], a[196:199], v[92:95], v[228:231]
  v_mfma_f32_16x16x32_bf16 v[232:235], a[104:107], v[88:91], v[8:11]
  v_mfma_f32_16x16x32_bf16 v[232:235], a[200:203], v[92:95], v[232:235]
  v_mfma_f32_16x16x32_bf16 v[236:239], a[108:111], v[88:91], v[8:11]
  v_mfma_f32_16x16x32_bf16 v[236:239], a[204:207], v[92:95], v[236:239]
  v_mfma_f32_16x16x32_bf16 v[240:243], a[112:115], v[88:91], v[8:11]
  v_mfma_f32_16x16x32_bf16 v[240:243], a[208:211], v[92:95], v[240:243]
  v_mfma_f32_16x16x32_bf16 v[244:247], a[116:119], v[88:91], v[8:11]
  v_mfma_f32_16x16x32_bf16 v[244:247], a[212:215], v[92:95], v[244:247]
  v_mfma_f32_16x16x32_bf16 v[248:251], a[120:123], v[88:91], v[8:11]
  v_mfma_f32_16x16x32_bf16 v[248:251], a[216:219], v[92:95], v[248:251]
  v_mfma_f32_16x16x32_bf16 v[252:255], a[124:127], v[88:91], v[8:11]
  v_cvt_pk_bf16_f32 v88, v120, v121
  v_mfma_f32_16x16x32_bf16 v[252:255], a[220:223], v[92:95], v[252:255]
  s_waitcnt vmcnt(8) lgkmcnt(0)
  s_barrier
.p2align 5
  s_nop 0
  s_nop 0
L_loop:
  v_mfma_f32_16x16x32_bf16 v[96:99], a[64:67], a[0:3], v[48:51]
  ds_read_b64_tr_b16 a[96:97], v36 offset:49152
  ds_read_b64_tr_b16 a[98:99], v36 offset:53248
  v_mfma_f32_16x16x32_bf16 v[96:99], a[68:71], a[4:7], v[96:99]
  v_exp_f32_e32 v123, v123
  v_mfma_f32_16x16x32_bf16 v[96:99], a[72:75], a[8:11], v[96:99]
  ds_read_b64_tr_b16 a[192:193], v36 offset:57344
  v_cvt_pk_bf16_f32 v89, v122, v123
  v_mfma_f32_16x16x32_bf16 v[96:99], a[76:79], a[12:15], v[96:99]
  v_exp_f32_e32 v124, v124
  v_mfma_f32_16x16x32_bf16 v[100:103], a[92:95], a[12:15], v[48:51]
  ds_read_b64_tr_b16 a[194:195], v36 offset:61440
  ds_read_b64_tr_b16 a[100:101], v37 offset:49152
  v_mfma_f32_16x16x32_bf16 v[100:103], a[88:91], a[8:11], v[100:103]
  v_exp_f32_e32 v125, v125
  v_mfma_f32_16x16x32_bf16 v[100:103], a[84:87], a[4:7], v[100:103]
  ds_read_b64_tr_b16 a[102:103], v37 offset:53248
  v_cvt_pk_bf16_f32 v90, v124, v125
  v_mfma_f32_16x16x32_bf16 v[100:103], a[80:83], a[0:3], v[100:103]
  v_exp_f32_e32 v126, v126
  v_mfma_f32_16x16x32_bf16 v[108:111], a[80:83], a[16:19], v[52:55]
  ds_read_b64_tr_b16 a[196:197], v37 offset:57344
  ds_read_b64_tr_b16 a[198:199], v37 offset:61440
  v_mfma_f32_16x16x32_bf16 v[108:111], a[84:87], a[20:23], v[108:111]
  v_exp_f32_e32 v127, v127
  v_mfma_f32_16x16x32_bf16 v[108:111], a[88:91], a[24:27], v[108:111]
  ds_read_b64_tr_b16 a[104:105], v38 offset:49152
  v_cvt_pk_bf16_f32 v91, v126, v127
  v_mfma_f32_16x16x32_bf16 v[108:111], a[92:95], a[28:31], v[108:111]
  ds_read_b64_tr_b16 a[106:107], v38 offset:53248
  ds_read_b64_tr_b16 a[200:201], v38 offset:57344
  v_mfma_f32_16x16x32_bf16 v[104:107], a[76:79], a[28:31], v[52:55]
  ds_read_b64_tr_b16 a[202:203], v38 offset:61440
  ds_read_b64_tr_b16 a[108:109], v39 offset:49152
  v_mfma_f32_16x16x32_bf16 v[104:107], a[72:75], a[24:27], v[104:107]
  v_exp_f32_e32 v96, v96
  v_mfma_f32_16x16x32_bf16 v[104:107], a[68:71], a[20:23], v[104:107]
  ds_read_b64_tr_b16 a[110:111], v39 offset:53248
  ds_read_b64_tr_b16 a[204:205], v39 offset:57344
  v_mfma_f32_16x16x32_bf16 v[104:107], a[64:67], a[16:19], v[104:107]
  v_exp_f32_e32 v97, v97
  v_mfma_f32_16x16x32_bf16 v[112:115], a[64:67], a[32:35], v[56:59]
  ds_read_b64_tr_b16 a[206:207], v39 offset:61440
  v_cvt_pk_bf16_f32 v68, v96, v97
  v_mfma_f32_16x16x32_bf16 v[112:115], a[68:71], a[36:39], v[112:115]
  v_exp_f32_e32 v98, v98
  v_mfma_f32_16x16x32_bf16 v[112:115], a[72:75], a[40:43], v[112:115]
  ds_read_b64_tr_b16 a[112:113], v40 offset:49152
  ds_read_b64_tr_b16 a[114:115], v40 offset:53248
  v_mfma_f32_16x16x32_bf16 v[112:115], a[76:79], a[44:47], v[112:115]
  v_exp_f32_e32 v99, v99
  v_mfma_f32_16x16x32_bf16 v[116:119], a[92:95], a[44:47], v[56:59]
  ds_read_b64_tr_b16 a[208:209], v40 offset:57344
  v_cvt_pk_bf16_f32 v69, v98, v99
  v_mfma_f32_16x16x32_bf16 v[116:119], a[88:91], a[40:43], v[116:119]
  v_exp_f32_e32 v100, v100
  v_mfma_f32_16x16x32_bf16 v[116:119], a[84:87], a[36:39], v[116:119]
  ds_read_b64_tr_b16 a[210:211], v40 offset:61440
  ds_read_b64_tr_b16 a[116:117], v41 offset:49152
  v_mfma_f32_16x16x32_bf16 v[116:119], a[80:83], a[32:35], v[116:119]
  v_exp_f32_e32 v101, v101
  v_mfma_f32_16x16x32_bf16 v[124:127], a[80:83], a[48:51], v[60:63]
  ds_read_b64_tr_b16 a[118:119], v41 offset:53248
  v_cvt_pk_bf16_f32 v70, v100, v101
  v_mfma_f32_16x16x32_bf16 v[124:127], a[84:87], a[52:55], v[124:127]
  v_exp_f32_e32 v102, v102
  v_mfma_f32_16x16x32_bf16 v[124:127], a[88:91], a[56:59], v[124:127]
  ds_read_b64_tr_b16 a[212:213], v41 offset:57344
  ds_read_b64_tr_b16 a[214:215], v41 offset:61440
  v_mfma_f32_16x16x32_bf16 v[124:127], a[92:95], a[60:63], v[124:127]
  v_exp_f32_e32 v103, v103
  v_mfma_f32_16x16x32_bf16 v[120:123], a[76:79], a[60:63], v[60:63]
  ds_read_b64_tr_b16 a[120:121], v42 offset:49152
  v_cvt_pk_bf16_f32 v71, v102, v103
  v_mfma_f32_16x16x32_bf16 v[120:123], a[72:75], a[56:59], v[120:123]
  v_exp_f32_e32 v104, v104
  v_mfma_f32_16x16x32_bf16 v[120:123], a[68:71], a[52:55], v[120:123]
  ds_read_b64_tr_b16 a[122:123], v42 offset:53248
  s_waitcnt lgkmcnt(5)
  v_mfma_f32_16x16x32_bf16 v[120:123], a[64:67], a[48:51], v[120:123]
  v_exp_f32_e32 v105, v105
  v_mfma_f32_16x16x32_bf16 v[128:131], a[192:195], v[68:71], v[128:131]
  ds_read_b64_tr_b16 a[216:217], v42 offset:57344
  v_cvt_pk_bf16_f32 v76, v104, v105
  v_mfma_f32_16x16x32_bf16 v[128:131], a[96:99], v[64:67], v[128:131]
  v_exp_f32_e32 v106, v106
  v_mfma_f32_16x16x32_bf16 v[132:135], a[100:103], v[64:67], v[132:135]
  ds_read_b64_tr_b16 a[218:219], v42 offset:61440
  ds_read_b64_tr_b16 a[124:125], v43 offset:49152
  v_mfma_f32_16x16x32_bf16 v[132:135], a[196:199], v[68:71], v[132:135]
  v_exp_f32_e32 v107, v107
  v_mfma_f32_16x16x32_bf16 v[136:139], a[200:203], v[68:71], v[136:139]
  ds_read_b64_tr_b16 a[126:127], v43 offset:53248
  v_cvt_pk_bf16_f32 v77, v106, v107
  v_mfma_f32_16x16x32_bf16 v[136:139], a[104:107], v[64:67], v[136:139]
  v_exp_f32_e32 v108, v108
  v_mfma_f32_16x16x32_bf16 v[140:143], a[108:111], v[64:67], v[140:143]
  ds_read_b64_tr_b16 a[220:221], v43 offset:57344
  ds_read_b64_tr_b16 a[222:223], v43 offset:61440
  v_mfma_f32_16x16x32_bf16 v[140:143], a[204:207], v[68:71], v[140:143]
  v_exp_f32_e32 v109, v109
  v_mfma_f32_16x16x32_bf16 v[144:147], a[208:211], v[68:71], v[144:147]
  s_waitcnt lgkmcnt(4)
  v_cvt_pk_bf16_f32 v78, v108, v109
  v_mfma_f32_16x16x32_bf16 v[144:147], a[112:115], v[64:67], v[144:147]
  v_exp_f32_e32 v110, v110
  v_mfma_f32_16x16x32_bf16 v[148:151], a[116:119], v[64:67], v[148:151]
  ds_read_b128 a[64:67], v32 offset:49152
  v_mfma_f32_16x16x32_bf16 v[148:151], a[212:215], v[68:71], v[148:151]
  v_exp_f32_e32 v111, v111
  v_mfma_f32_16x16x32_bf16 v[152:155], a[216:219], v[68:71], v[152:155]
  s_waitcnt lgkmcnt(1)
  v_cvt_pk_bf16_f32 v79, v110, v111
  v_mfma_f32_16x16x32_bf16 v[152:155], a[120:123], v[64:67], v[152:155]
  v_exp_f32_e32 v112, v112
  v_mfma_f32_16x16x32_bf16 v[156:159], a[124:127], v[64:67], v[156:159]
  ds_read_b128 a[68:71], v33 offset:49152
  ds_read_b128 a[72:75], v34 offset:49152
  v_mfma_f32_16x16x32_bf16 v[156:159], a[220:223], v[68:71], v[156:159]
  v_exp_f32_e32 v113, v113
  v_smfmac_f32_16x16x64_bf16 a[128:131], a[144:147], v[64:71], v29
  ds_read_b128 a[76:79], v35 offset:49152
  v_cvt_pk_bf16_f32 v84, v112, v113
  v_mfma_f32_16x16x32_bf16 v[160:163], a[192:195], v[76:79], v[160:163]
  v_exp_f32_e32 v114, v114
  v_mfma_f32_16x16x32_bf16 v[160:163], a[96:99], v[72:75], v[160:163]
  ds_read_b128 a[80:83], v32 offset:53248
  v_mfma_f32_16x16x32_bf16 v[164:167], a[100:103], v[72:75], v[164:167]
  v_exp_f32_e32 v115, v115
  v_mfma_f32_16x16x32_bf16 v[164:167], a[196:199], v[76:79], v[164:167]
  ds_read_b128 a[84:87], v33 offset:53248
  v_cvt_pk_bf16_f32 v85, v114, v115
  v_mfma_f32_16x16x32_bf16 v[168:171], a[200:203], v[76:79], v[168:171]
  v_exp_f32_e32 v116, v116
  v_mfma_f32_16x16x32_bf16 v[168:171], a[104:107], v[72:75], v[168:171]
  ds_read_b128 a[88:91], v34 offset:53248
  v_mfma_f32_16x16x32_bf16 v[172:175], a[108:111], v[72:75], v[172:175]
  v_exp_f32_e32 v117, v117
  v_mfma_f32_16x16x32_bf16 v[172:175], a[204:207], v[76:79], v[172:175]
  ds_read_b128 a[92:95], v35 offset:53248
  v_cvt_pk_bf16_f32 v86, v116, v117
  v_mfma_f32_16x16x32_bf16 v[176:179], a[208:211], v[76:79], v[176:179]
  v_exp_f32_e32 v118, v118
  v_mfma_f32_16x16x32_bf16 v[176:179], a[112:115], v[72:75], v[176:179]
  s_mov_b32 m0, s29
  v_add_u32 v22, 1, v22
  v_mfma_f32_16x16x32_bf16 v[180:183], a[116:119], v[72:75], v[180:183]
  v_exp_f32_e32 v119, v119
  v_mfma_f32_16x16x32_bf16 v[180:183], a[212:215], v[76:79], v[180:183]
  v_cvt_pk_bf16_f32 v87, v118, v119
  v_mfma_f32_16x16x32_bf16 v[184:187], a[216:219], v[76:79], v[184:187]
  v_exp_f32_e32 v120, v120
  v_mfma_f32_16x16x32_bf16 v[184:187], a[120:123], v[72:75], v[184:187]
  s_waitcnt vmcnt(0) lgkmcnt(0)
  ds_write_b32 v20, v22
  v_mfma_f32_16x16x32_bf16 v[188:191], a[124:127], v[72:75], v[188:191]
  v_exp_f32_e32 v121, v121
  v_mfma_f32_16x16x32_bf16 v[188:191], a[220:223], v[76:79], v[188:191]
  v_cvt_pk_bf16_f32 v92, v120, v121
  v_smfmac_f32_16x16x64_bf16 a[132:135], a[144:147], v[72:79], v29
  v_exp_f32_e32 v122, v122
  v_mfma_f32_16x16x32_bf16 v[96:99], a[64:67], a[0:3], v[48:51]
  buffer_load_dwordx4 v44, s[16:19], s37 offen offset:0 lds
  v_mfma_f32_16x16x32_bf16 v[96:99], a[68:71], a[4:7], v[96:99]
  v_exp_f32_e32 v123, v123
  v_mfma_f32_16x16x32_bf16 v[96:99], a[72:75], a[8:11], v[96:99]
  v_cvt_pk_bf16_f32 v93, v122, v123
  v_mfma_f32_16x16x32_bf16 v[96:99], a[76:79], a[12:15], v[96:99]
  v_exp_f32_e32 v124, v124
  v_mfma_f32_16x16x32_bf16 v[100:103], a[92:95], a[12:15], v[48:51]
  buffer_load_dwordx4 v45, s[16:19], s37 offen offset:1024 lds
  v_mfma_f32_16x16x32_bf16 v[100:103], a[88:91], a[8:11], v[100:103]
  v_exp_f32_e32 v125, v125
  v_mfma_f32_16x16x32_bf16 v[100:103], a[84:87], a[4:7], v[100:103]
  v_cvt_pk_bf16_f32 v94, v124, v125
  v_mfma_f32_16x16x32_bf16 v[100:103], a[80:83], a[0:3], v[100:103]
  v_exp_f32_e32 v126, v126
  v_mfma_f32_16x16x32_bf16 v[108:111], a[80:83], a[16:19], v[52:55]
  buffer_load_dwordx4 v46, s[16:19], s37 offen offset:2048 lds
  v_mfma_f32_16x16x32_bf16 v[108:111], a[84:87], a[20:23], v[108:111]
  v_exp_f32_e32 v127, v127
  v_mfma_f32_16x16x32_bf16 v[108:111], a[88:91], a[24:27], v[108:111]
  v_cvt_pk_bf16_f32 v95, v126, v127
  v_mfma_f32_16x16x32_bf16 v[108:111], a[92:95], a[28:31], v[108:111]
  buffer_load_dwordx4 v47, s[16:19], s37 offen offset:3072 lds
  v_mfma_f32_16x16x32_bf16 v[104:107], a[76:79], a[28:31], v[52:55]
  s_mov_b32 m0, s33
  v_mfma_f32_16x16x32_bf16 v[104:107], a[72:75], a[24:27], v[104:107]
  v_exp_f32_e32 v96, v96
  v_mfma_f32_16x16x32_bf16 v[104:107], a[68:71], a[20:23], v[104:107]
  buffer_load_dwordx4 v30, s[20:23], s36 offen offset:0 lds
  v_mfma_f32_16x16x32_bf16 v[104:107], a[64:67], a[16:19], v[104:107]
  v_exp_f32_e32 v97, v97
  v_mfma_f32_16x16x32_bf16 v[112:115], a[64:67], a[32:35], v[56:59]
  v_cvt_pk_bf16_f32 v64, v96, v97
  v_mfma_f32_16x16x32_bf16 v[112:115], a[68:71], a[36:39], v[112:115]
  v_exp_f32_e32 v98, v98
  v_mfma_f32_16x16x32_bf16 v[112:115], a[72:75], a[40:43], v[112:115]
  buffer_load_dwordx4 v31, s[20:23], s36 offen offset:1024 lds
  v_mfma_f32_16x16x32_bf16 v[112:115], a[76:79], a[44:47], v[112:115]
  v_exp_f32_e32 v99, v99
  v_mfma_f32_16x16x32_bf16 v[116:119], a[92:95], a[44:47], v[56:59]
  v_cvt_pk_bf16_f32 v65, v98, v99
  v_mfma_f32_16x16x32_bf16 v[116:119], a[88:91], a[40:43], v[116:119]
  v_exp_f32_e32 v100, v100
  v_mfma_f32_16x16x32_bf16 v[116:119], a[84:87], a[36:39], v[116:119]
  buffer_load_dwordx4 v30, s[20:23], s36 offen offset:2048 lds
  v_mfma_f32_16x16x32_bf16 v[116:119], a[80:83], a[32:35], v[116:119]
  v_exp_f32_e32 v101, v101
  v_mfma_f32_16x16x32_bf16 v[124:127], a[80:83], a[48:51], v[60:63]
  v_cvt_pk_bf16_f32 v66, v100, v101
  v_mfma_f32_16x16x32_bf16 v[124:127], a[84:87], a[52:55], v[124:127]
  v_exp_f32_e32 v102, v102
  v_mfma_f32_16x16x32_bf16 v[124:127], a[88:91], a[56:59], v[124:127]
  buffer_load_dwordx4 v31, s[20:23], s36 offen offset:3072 lds
  v_mfma_f32_16x16x32_bf16 v[124:127], a[92:95], a[60:63], v[124:127]
  v_exp_f32_e32 v103, v103
  v_mfma_f32_16x16x32_bf16 v[120:123], a[76:79], a[60:63], v[60:63]
  v_cvt_pk_bf16_f32 v67, v102, v103
  v_mfma_f32_16x16x32_bf16 v[120:123], a[72:75], a[56:59], v[120:123]
  v_exp_f32_e32 v104, v104
  v_mfma_f32_16x16x32_bf16 v[120:123], a[68:71], a[52:55], v[120:123]
  v_mfma_f32_16x16x32_bf16 v[120:123], a[64:67], a[48:51], v[120:123]
  v_exp_f32_e32 v105, v105
  v_smfmac_f32_16x16x64_bf16 a[136:139], a[144:147], v[80:87], v29
  v_cvt_pk_bf16_f32 v72, v104, v105
  v_mfma_f32_16x16x32_bf16 v[192:195], a[192:195], v[84:87], v[192:195]
  v_exp_f32_e32 v106, v106
  v_mfma_f32_16x16x32_bf16 v[192:195], a[96:99], v[80:83], v[192:195]
  ds_read_b128 a[64:67], v32 offset:57344
  v_mfma_f32_16x16x32_bf16 v[196:199], a[100:103], v[80:83], v[196:199]
  v_exp_f32_e32 v107, v107
  v_mfma_f32_16x16x32_bf16 v[196:199], a[196:199], v[84:87], v[196:199]
  ds_read_b128 a[68:71], v33 offset:57344
  v_cvt_pk_bf16_f32 v73, v106, v107
  v_mfma_f32_16x16x32_bf16 v[200:203], a[200:203], v[84:87], v[200:203]
  v_exp_f32_e32 v108, v108
  v_mfma_f32_16x16x32_bf16 v[200:203], a[104:107], v[80:83], v[200:203]
  ds_read_b128 a[72:75], v34 offset:57344
  v_mfma_f32_16x16x32_bf16 v[204:207], a[108:111], v[80:83], v[204:207]
  v_exp_f32_e32 v109, v109
  v_mfma_f32_16x16x32_bf16 v[204:207], a[204:207], v[84:87], v[204:207]
  ds_read_b128 a[76:79], v35 offset:57344
  v_cvt_pk_bf16_f32 v74, v108, v109
  v_mfma_f32_16x16x32_bf16 v[208:211], a[208:211], v[84:87], v[208:211]
  v_exp_f32_e32 v110, v110
  v_mfma_f32_16x16x32_bf16 v[208:211], a[112:115], v[80:83], v[208:211]
  ds_read_b128 a[80:83], v32 offset:61440
  v_mfma_f32_16x16x32_bf16 v[212:215], a[116:119], v[80:83], v[212:215]
  v_exp_f32_e32 v111, v111
  v_mfma_f32_16x16x32_bf16 v[212:215], a[212:215], v[84:87], v[212:215]
  ds_read_b128 a[84:87], v33 offset:61440
  v_cvt_pk_bf16_f32 v75, v110, v111
  v_mfma_f32_16x16x32_bf16 v[216:219], a[216:219], v[84:87], v[216:219]
  v_exp_f32_e32 v112, v112
  v_mfma_f32_16x16x32_bf16 v[216:219], a[120:123], v[80:83], v[216:219]
  ds_read_b128 a[88:91], v34 offset:61440
  v_mfma_f32_16x16x32_bf16 v[220:223], a[124:127], v[80:83], v[220:223]
  v_exp_f32_e32 v113, v113
  v_mfma_f32_16x16x32_bf16 v[220:223], a[220:223], v[84:87], v[220:223]
  ds_read_b128 a[92:95], v35 offset:61440
  v_cvt_pk_bf16_f32 v80, v112, v113
  v_smfmac_f32_16x16x64_bf16 a[140:143], a[144:147], v[88:95], v29
  v_exp_f32_e32 v114, v114
  v_mfma_f32_16x16x32_bf16 v[224:227], a[192:195], v[92:95], v[224:227]
  ds_read_b32 v23, v21
  v_mfma_f32_16x16x32_bf16 v[224:227], a[96:99], v[88:91], v[224:227]
  v_exp_f32_e32 v115, v115
  v_mfma_f32_16x16x32_bf16 v[228:231], a[100:103], v[88:91], v[228:231]
  v_cvt_pk_bf16_f32 v81, v114, v115
  v_mfma_f32_16x16x32_bf16 v[228:231], a[196:199], v[92:95], v[228:231]
  v_exp_f32_e32 v116, v116
  v_mfma_f32_16x16x32_bf16 v[232:235], a[200:203], v[92:95], v[232:235]
  s_add_u32 s36, s37, 0x4000
  s_bitset0_b32 s36, 19
  v_mfma_f32_16x16x32_bf16 v[232:235], a[104:107], v[88:91], v[232:235]
  v_exp_f32_e32 v117, v117
  v_mfma_f32_16x16x32_bf16 v[236:239], a[108:111], v[88:91], v[236:239]
  v_cvt_pk_bf16_f32 v82, v116, v117
  v_mfma_f32_16x16x32_bf16 v[236:239], a[204:207], v[92:95], v[236:239]
  v_exp_f32_e32 v118, v118
  v_mfma_f32_16x16x32_bf16 v[240:243], a[208:211], v[92:95], v[240:243]
  s_waitcnt lgkmcnt(0)
  v_cmp_gt_u32 vcc, v22, v23
  v_mfma_f32_16x16x32_bf16 v[240:243], a[112:115], v[88:91], v[240:243]
  v_exp_f32_e32 v119, v119
  v_mfma_f32_16x16x32_bf16 v[244:247], a[116:119], v[88:91], v[244:247]
  v_cvt_pk_bf16_f32 v83, v118, v119
  v_mfma_f32_16x16x32_bf16 v[244:247], a[212:215], v[92:95], v[244:247]
  v_exp_f32_e32 v120, v120
  v_mfma_f32_16x16x32_bf16 v[248:251], a[216:219], v[92:95], v[248:251]
  s_cbranch_vccnz L_wait3
L_go3:
  v_mfma_f32_16x16x32_bf16 v[248:251], a[120:123], v[88:91], v[248:251]
  v_exp_f32_e32 v121, v121
  v_mfma_f32_16x16x32_bf16 v[252:255], a[124:127], v[88:91], v[252:255]
  v_cvt_pk_bf16_f32 v88, v120, v121
  v_mfma_f32_16x16x32_bf16 v[252:255], a[220:223], v[92:95], v[252:255]
  v_exp_f32_e32 v122, v122
  v_mfma_f32_16x16x32_bf16 v[96:99], a[64:67], a[0:3], v[48:51]
  ds_read_b64_tr_b16 a[96:97], v36 offset:0
  ds_read_b64_tr_b16 a[98:99], v36 offset:4096
  v_mfma_f32_16x16x32_bf16 v[96:99], a[68:71], a[4:7], v[96:99]
  v_exp_f32_e32 v123, v123
  v_mfma_f32_16x16x32_bf16 v[96:99], a[72:75], a[8:11], v[96:99]
  ds_read_b64_tr_b16 a[192:193], v36 offset:8192
  v_cvt_pk_bf16_f32 v89, v122, v123
  v_mfma_f32_16x16x32_bf16 v[96:99], a[76:79], a[12:15], v[96:99]
  v_exp_f32_e32 v124, v124
  v_mfma_f32_16x16x32_bf16 v[100:103], a[92:95], a[12:15], v[48:51]
  ds_read_b64_tr_b16 a[194:195], v36 offset:12288
  ds_read_b64_tr_b16 a[100:101], v37 offset:0
  v_mfma_f32_16x16x32_bf16 v[100:103], a[88:91], a[8:11], v[100:103]
  v_exp_f32_e32 v125, v125
  v_mfma_f32_16x16x32_bf16 v[100:103], a[84:87], a[4:7], v[100:103]
  ds_read_b64_tr_b16 a[102:103], v37 offset:4096
  v_cvt_pk_bf16_f32 v90, v124, v125
  v_mfma_f32_16x16x32_bf16 v[100:103], a[80:83], a[0:3], v[100:103]
  v_exp_f32_e32 v126, v126
  v_mfma_f32_16x16x32_bf16 v[108:111], a[80:83], a[16:19], v[52:55]
  ds_read_b64_tr_b16 a[196:197], v37 offset:8192
  ds_read_b64_tr_b16 a[198:199], v37 offset:12288
  v_mfma_f32_16x16x32_bf16 v[108:111], a[84:87], a[20:23], v[108:111]
  v_exp_f32_e32 v127, v127
  v_mfma_f32_16x16x32_bf16 v[108:111], a[88:91], a[24:27], v[108:111]
  ds_read_b64_tr_b16 a[104:105], v38 offset:0
  v_cvt_pk_bf16_f32 v91, v126, v127
  v_mfma_f32_16x16x32_bf16 v[108:111], a[92:95], a[28:31], v[108:111]
  ds_read_b64_tr_b16 a[106:107], v38 offset:4096
  ds_read_b64_tr_b16 a[200:201], v38 offset:8192
  v_mfma_f32_16x16x32_bf16 v[104:107], a[76:79], a[28:31], v[52:55]
  ds_read_b64_tr_b16 a[202:203], v38 offset:12288
  ds_read_b64_tr_b16 a[108:109], v39 offset:0
  v_mfma_f32_16x16x32_bf16 v[104:107], a[72:75], a[24:27], v[104:107]
  v_exp_f32_e32 v96, v96
  v_mfma_f32_16x16x32_bf16 v[104:107], a[68:71], a[20:23], v[104:107]
  ds_read_b64_tr_b16 a[110:111], v39 offset:4096
  ds_read_b64_tr_b16 a[204:205], v39 offset:8192
  v_mfma_f32_16x16x32_bf16 v[104:107], a[64:67], a[16:19], v[104:107]
  v_exp_f32_e32 v97, v97
  v_mfma_f32_16x16x32_bf16 v[112:115], a[64:67], a[32:35], v[56:59]
  ds_read_b64_tr_b16 a[206:207], v39 offset:12288
  v_cvt_pk_bf16_f32 v68, v96, v97
  v_mfma_f32_16x16x32_bf16 v[112:115], a[68:71], a[36:39], v[112:115]
  v_exp_f32_e32 v98, v98
  v_mfma_f32_16x16x32_bf16 v[112:115], a[72:75], a[40:43], v[112:115]
  ds_read_b64_tr_b16 a[112:113], v40 offset:0
  ds_read_b64_tr_b16 a[114:115], v40 offset:4096
  v_mfma_f32_16x16x32_bf16 v[112:115], a[76:79], a[44:47], v[112:115]
  v_exp_f32_e32 v99, v99
  v_mfma_f32_16x16x32_bf16 v[116:119], a[92:95], a[44:47], v[56:59]
  ds_read_b64_tr_b16 a[208:209], v40 offset:8192
  v_cvt_pk_bf16_f32 v69, v98, v99
  v_mfma_f32_16x16x32_bf16 v[116:119], a[88:91], a[40:43], v[116:119]
  v_exp_f32_e32 v100, v100
  v_mfma_f32_16x16x32_bf16 v[116:119], a[84:87], a[36:39], v[116:119]
  ds_read_b64_tr_b16 a[210:211], v40 offset:12288
  ds_read_b64_tr_b16 a[116:117], v41 offset:0
  v_mfma_f32_16x16x32_bf16 v[116:119], a[80:83], a[32:35], v[116:119]
  v_exp_f32_e32 v101, v101
  v_mfma_f32_16x16x32_bf16 v[124:127], a[80:83], a[48:51], v[60:63]
  ds_read_b64_tr_b16 a[118:119], v41 offset:4096
  v_cvt_pk_bf16_f32 v70, v100, v101
  v_mfma_f32_16x16x32_bf16 v[124:127], a[84:87], a[52:55], v[124:127]
  v_exp_f32_e32 v102, v102
  v_mfma_f32_16x16x32_bf16 v[124:127], a[88:91], a[56:59], v[124:127]
  ds_read_b64_tr_b16 a[212:213], v41 offset:8192
  ds_read_b64_tr_b16 a[214:215], v41 offset:12288
  v_mfma_f32_16x16x32_bf16 v[124:127], a[92:95], a[60:63], v[124:127]
  v_exp_f32_e32 v103, v103
  v_mfma_f32_16x16x32_bf16 v[120:123], a[76:79], a[60:63], v[60:63]
  ds_read_b64_tr_b16 a[120:121], v42 offset:0
  v_cvt_pk_bf16_f32 v71, v102, v103
  v_mfma_f32_16x16x32_bf16 v[120:123], a[72:75], a[56:59], v[120:123]
  v_exp_f32_e32 v104, v104
  v_mfma_f32_16x16x32_bf16 v[120:123], a[68:71], a[52:55], v[120:123]
  ds_read_b64_tr_b16 a[122:123], v42 offset:4096
  s_waitcnt lgkmcnt(5)
  v_mfma_f32_16x16x32_bf16 v[120:123], a[64:67], a[48:51], v[120:123]
  v_exp_f32_e32 v105, v105
  v_mfma_f32_16x16x32_bf16 v[128:131], a[192:195], v[68:71], v[128:131]
  ds_read_b64_tr_b16 a[216:217], v42 offset:8192
  v_cvt_pk_bf16_f32 v76, v104, v105
  v_mfma_f32_16x16x32_bf16 v[128:131], a[96:99], v[64:67], v[128:131]
  v_exp_f32_e32 v106, v106
  v_mfma_f32_16x16x32_bf16 v[132:135], a[100:103], v[64:67], v[132:135]
  ds_read_b64_tr_b16 a[218:219], v42 offset:12288
  ds_read_b64_tr_b16 a[124:125], v43 offset:0
  v_mfma_f32_16x16x32_bf16 v[132:135], a[196:199], v[68:71], v[132:135]
  v_exp_f32_e32 v107, v107
  v_mfma_f32_16x16x32_bf16 v[136:139], a[200:203], v[68:71], v[136:139]
  ds_read_b64_tr_b16 a[126:127], v43 offset:4096
  v_cvt_pk_bf16_f32 v77, v106, v107
  v_mfma_f32_16x16x32_bf16 v[136:139], a[104:107], v[64:67], v[136:139]
  v_exp_f32_e32 v108, v108
  v_mfma_f32_16x16x32_bf16 v[140:143], a[108:111], v[64:67], v[140:143]
  ds_read_b64_tr_b16 a[220:221], v43 offset:8192
  ds_read_b64_tr_b16 a[222:223], v43 offset:12288
  v_mfma_f32_16x16x32_bf16 v[140:143], a[204:207], v[68:71], v[140:143]
  v_exp_f32_e32 v109, v109
  v_mfma_f32_16x16x32_bf16 v[144:147], a[208:211], v[68:71], v[144:147]
  s_waitcnt lgkmcnt(4)
  v_cvt_pk_bf16_f32 v78, v108, v109
  v_mfma_f32_16x16x32_bf16 v[144:147], a[112:115], v[64:67], v[144:147]
  v_exp_f32_e32 v110, v110
  v_mfma_f32_16x16x32_bf16 v[148:151], a[116:119], v[64:67], v[148:151]
  ds_read_b128 a[64:67], v32 offset:0
  v_mfma_f32_16x16x32_bf16 v[148:151], a[212:215], v[68:71], v[148:151]
  v_exp_f32_e32 v111, v111
  v_mfma_f32_16x16x32_bf16 v[152:155], a[216:219], v[68:71], v[152:155]
  s_waitcnt lgkmcnt(1)
  v_cvt_pk_bf16_f32 v79, v110, v111
  v_mfma_f32_16x16x32_bf16 v[152:155], a[120:123], v[64:67], v[152:155]
  v_exp_f32_e32 v112, v112
  v_mfma_f32_16x16x32_bf16 v[156:159], a[124:127], v[64:67], v[156:159]
  ds_read_b128 a[68:71], v33 offset:0
  ds_read_b128 a[72:75], v34 offset:0
  v_mfma_f32_16x16x32_bf16 v[156:159], a[220:223], v[68:71], v[156:159]
  v_exp_f32_e32 v113, v113
  v_smfmac_f32_16x16x64_bf16 a[128:131], a[144:147], v[64:71], v29
  ds_read_b128 a[76:79], v35 offset:0
  v_cvt_pk_bf16_f32 v84, v112, v113
  v_mfma_f32_16x16x32_bf16 v[160:163], a[192:195], v[76:79], v[160:163]
  v_exp_f32_e32 v114, v114
  v_mfma_f32_16x16x32_bf16 v[160:163], a[96:99], v[72:75], v[160:163]
  ds_read_b128 a[80:83], v32 offset:4096
  v_mfma_f32_16x16x32_bf16 v[164:167], a[100:103], v[72:75], v[164:167]
  v_exp_f32_e32 v115, v115
  v_mfma_f32_16x16x32_bf16 v[164:167], a[196:199], v[76:79], v[164:167]
  ds_read_b128 a[84:87], v33 offset:4096
  v_cvt_pk_bf16_f32 v85, v114, v115
  v_mfma_f32_16x16x32_bf16 v[168:171], a[200:203], v[76:79], v[168:171]
  v_exp_f32_e32 v116, v116
  v_mfma_f32_16x16x32_bf16 v[168:171], a[104:107], v[72:75], v[168:171]
  ds_read_b128 a[88:91], v34 offset:4096
  v_mfma_f32_16x16x32_bf16 v[172:175], a[108:111], v[72:75], v[172:175]
  v_exp_f32_e32 v117, v117
  v_mfma_f32_16x16x32_bf16 v[172:175], a[204:207], v[76:79], v[172:175]
  ds_read_b128 a[92:95], v35 offset:4096
  v_cvt_pk_bf16_f32 v86, v116, v117
  v_mfma_f32_16x16x32_bf16 v[176:179], a[208:211], v[76:79], v[176:179]
  v_exp_f32_e32 v118, v118
  v_mfma_f32_16x16x32_bf16 v[176:179], a[112:115], v[72:75], v[176:179]
  s_mov_b32 m0, s30
  v_add_u32 v22, 1, v22
  v_mfma_f32_16x16x32_bf16 v[180:183], a[116:119], v[72:75], v[180:183]
  v_exp_f32_e32 v119, v119
  v_mfma_f32_16x16x32_bf16 v[180:183], a[212:215], v[76:79], v[180:183]
  v_cvt_pk_bf16_f32 v87, v118, v119
  v_mfma_f32_16x16x32_bf16 v[184:187], a[216:219], v[76:79], v[184:187]
  v_exp_f32_e32 v120, v120
  v_mfma_f32_16x16x32_bf16 v[184:187], a[120:123], v[72:75], v[184:187]
  s_waitcnt vmcnt(0) lgkmcnt(0)
  ds_write_b32 v20, v22
  v_mfma_f32_16x16x32_bf16 v[188:191], a[124:127], v[72:75], v[188:191]
  v_exp_f32_e32 v121, v121
  v_mfma_f32_16x16x32_bf16 v[188:191], a[220:223], v[76:79], v[188:191]
  v_cvt_pk_bf16_f32 v92, v120, v121
  v_smfmac_f32_16x16x64_bf16 a[132:135], a[144:147], v[72:79], v29
  v_exp_f32_e32 v122, v122
  v_mfma_f32_16x16x32_bf16 v[96:99], a[64:67], a[0:3], v[48:51]
  buffer_load_dwordx4 v44, s[16:19], s36 offen offset:0 lds
  v_mfma_f32_16x16x32_bf16 v[96:99], a[68:71], a[4:7], v[96:99]
  v_exp_f32_e32 v123, v123
  v_mfma_f32_16x16x32_bf16 v[96:99], a[72:75], a[8:11], v[96:99]
  v_cvt_pk_bf16_f32 v93, v122, v123
  v_mfma_f32_16x16x32_bf16 v[96:99], a[76:79], a[12:15], v[96:99]
  v_exp_f32_e32 v124, v124
  v_mfma_f32_16x16x32_bf16 v[100:103], a[92:95], a[12:15], v[48:51]
  buffer_load_dwordx4 v45, s[16:19], s36 offen offset:1024 lds
  v_mfma_f32_16x16x32_bf16 v[100:103], a[88:91], a[8:11], v[100:103]
  v_exp_f32_e32 v125, v125
  v_mfma_f32_16x16x32_bf16 v[100:103], a[84:87], a[4:7], v[100:103]
  v_cvt_pk_bf16_f32 v94, v124, v125
  v_mfma_f32_16x16x32_bf16 v[100:103], a[80:83], a[0:3], v[100:103]
  v_exp_f32_e32 v126, v126
  v_mfma_f32_16x16x32_bf16 v[108:111], a[80:83], a[16:19], v[52:55]
  buffer_load_dwordx4 v46, s[16:19], s36 offen offset:2048 lds
  v_mfma_f32_16x16x32_bf16 v[108:111], a[84:87], a[20:23], v[108:111]
  v_exp_f32_e32 v127, v127
  v_mfma_f32_16x16x32_bf16 v[108:111], a[88:91], a[24:27], v[108:111]
  v_cvt_pk_bf16_f32 v95, v126, v127
  v_mfma_f32_16x16x32_bf16 v[108:111], a[92:95], a[28:31], v[108:111]
  buffer_load_dwordx4 v47, s[16:19], s36 offen offset:3072 lds
  v_mfma_f32_16x16x32_bf16 v[104:107], a[76:79], a[28:31], v[52:55]
  s_mov_b32 m0, s34
  v_mfma_f32_16x16x32_bf16 v[104:107], a[72:75], a[24:27], v[104:107]
  v_exp_f32_e32 v96, v96
  v_mfma_f32_16x16x32_bf16 v[104:107], a[68:71], a[20:23], v[104:107]
  buffer_load_dwordx4 v30, s[20:23], s37 offen offset:0 lds
  v_mfma_f32_16x16x32_bf16 v[104:107], a[64:67], a[16:19], v[104:107]
  v_exp_f32_e32 v97, v97
  v_mfma_f32_16x16x32_bf16 v[112:115], a[64:67], a[32:35], v[56:59]
  v_cvt_pk_bf16_f32 v64, v96, v97
  v_mfma_f32_16x16x32_bf16 v[112:115], a[68:71], a[36:39], v[112:115]
  v_exp_f32_e32 v98, v98
  v_mfma_f32_16x16x32_bf16 v[112:115], a[72:75], a[40:43], v[112:115]
  buffer_load_dwordx4 v31, s[20:23], s37 offen offset:1024 lds
  v_mfma_f32_16x16x32_bf16 v[112:115], a[76:79], a[44:47], v[112:115]
  v_exp_f32_e32 v99, v99
  v_mfma_f32_16x16x32_bf16 v[116:119], a[92:95], a[44:47], v[56:59]
  v_cvt_pk_bf16_f32 v65, v98, v99
  v_mfma_f32_16x16x32_bf16 v[116:119], a[88:91], a[40:43], v[116:119]
  v_exp_f32_e32 v100, v100
  v_mfma_f32_16x16x32_bf16 v[116:119], a[84:87], a[36:39], v[116:119]
  buffer_load_dwordx4 v30, s[20:23], s37 offen offset:2048 lds
  v_mfma_f32_16x16x32_bf16 v[116:119], a[80:83], a[32:35], v[116:119]
  v_exp_f32_e32 v101, v101
  v_mfma_f32_16x16x32_bf16 v[124:127], a[80:83], a[48:51], v[60:63]
  v_cvt_pk_bf16_f32 v66, v100, v101
  v_mfma_f32_16x16x32_bf16 v[124:127], a[84:87], a[52:55], v[124:127]
  v_exp_f32_e32 v102, v102
  v_mfma_f32_16x16x32_bf16 v[124:127], a[88:91], a[56:59], v[124:127]
  buffer_load_dwordx4 v31, s[20:23], s37 offen offset:3072 lds
  v_mfma_f32_16x16x32_bf16 v[124:127], a[92:95], a[60:63], v[124:127]
  v_exp_f32_e32 v103, v103
  v_mfma_f32_16x16x32_bf16 v[120:123], a[76:79], a[60:63], v[60:63]
  v_cvt_pk_bf16_f32 v67, v102, v103
  v_mfma_f32_16x16x32_bf16 v[120:123], a[72:75], a[56:59], v[120:123]
  v_exp_f32_e32 v104, v104
  v_mfma_f32_16x16x32_bf16 v[120:123], a[68:71], a[52:55], v[120:123]
  v_mfma_f32_16x16x32_bf16 v[120:123], a[64:67], a[48:51], v[120:123]
  v_exp_f32_e32 v105, v105
  v_smfmac_f32_16x16x64_bf16 a[136:139], a[144:147], v[80:87], v29
  v_cvt_pk_bf16_f32 v72, v104, v105
  v_mfma_f32_16x16x32_bf16 v[192:195], a[192:195], v[84:87], v[192:195]
  v_exp_f32_e32 v106, v106
  v_mfma_f32_16x16x32_bf16 v[192:195], a[96:99], v[80:83], v[192:195]
  ds_read_b128 a[64:67], v32 offset:8192
  v_mfma_f32_16x16x32_bf16 v[196:199], a[100:103], v[80:83], v[196:199]
  v_exp_f32_e32 v107, v107
  v_mfma_f32_16x16x32_bf16 v[196:199], a[196:199], v[84:87], v[196:199]
  ds_read_b128 a[68:71], v33 offset:8192
  v_cvt_pk_bf16_f32 v73, v106, v107
  v_mfma_f32_16x16x32_bf16 v[200:203], a[200:203], v[84:87], v[200:203]
  v_exp_f32_e32 v108, v108
  v_mfma_f32_16x16x32_bf16 v[200:203], a[104:107], v[80:83], v[200:203]
  ds_read_b128 a[72:75], v34 offset:8192
  v_mfma_f32_16x16x32_bf16 v[204:207], a[108:111], v[80:83], v[204:207]
  v_exp_f32_e32 v109, v109
  v_mfma_f32_16x16x32_bf16 v[204:207], a[204:207], v[84:87], v[204:207]
  ds_read_b128 a[76:79], v35 offset:8192
  v_cvt_pk_bf16_f32 v74, v108, v109
  v_mfma_f32_16x16x32_bf16 v[208:211], a[208:211], v[84:87], v[208:211]
  v_exp_f32_e32 v110, v110
  v_mfma_f32_16x16x32_bf16 v[208:211], a[112:115], v[80:83], v[208:211]
  ds_read_b128 a[80:83], v32 offset:12288
  v_mfma_f32_16x16x32_bf16 v[212:215], a[116:119], v[80:83], v[212:215]
  v_exp_f32_e32 v111, v111
  v_mfma_f32_16x16x32_bf16 v[212:215], a[212:215], v[84:87], v[212:215]
  ds_read_b128 a[84:87], v33 offset:12288
  v_cvt_pk_bf16_f32 v75, v110, v111
  v_mfma_f32_16x16x32_bf16 v[216:219], a[216:219], v[84:87], v[216:219]
  v_exp_f32_e32 v112, v112
  v_mfma_f32_16x16x32_bf16 v[216:219], a[120:123], v[80:83], v[216:219]
  ds_read_b128 a[88:91], v34 offset:12288
  v_mfma_f32_16x16x32_bf16 v[220:223], a[124:127], v[80:83], v[220:223]
  v_exp_f32_e32 v113, v113
  v_mfma_f32_16x16x32_bf16 v[220:223], a[220:223], v[84:87], v[220:223]
  ds_read_b128 a[92:95], v35 offset:12288
  v_cvt_pk_bf16_f32 v80, v112, v113
  v_smfmac_f32_16x16x64_bf16 a[140:143], a[144:147], v[88:95], v29
  v_exp_f32_e32 v114, v114
  v_mfma_f32_16x16x32_bf16 v[224:227], a[192:195], v[92:95], v[224:227]
  ds_read_b32 v23, v21
  v_mfma_f32_16x16x32_bf16 v[224:227], a[96:99], v[88:91], v[224:227]
  v_exp_f32_e32 v115, v115
  v_mfma_f32_16x16x32_bf16 v[228:231], a[100:103], v[88:91], v[228:231]
  v_cvt_pk_bf16_f32 v81, v114, v115
  v_mfma_f32_16x16x32_bf16 v[228:231], a[196:199], v[92:95], v[228:231]
  v_exp_f32_e32 v116, v116
  v_mfma_f32_16x16x32_bf16 v[232:235], a[200:203], v[92:95], v[232:235]
  s_add_u32 s37, s36, 0x4000
  s_bitset0_b32 s37, 19
  v_mfma_f32_16x16x32_bf16 v[232:235], a[104:107], v[88:91], v[232:235]
  v_exp_f32_e32 v117, v117
  v_mfma_f32_16x16x32_bf16 v[236:239], a[108:111], v[88:91], v[236:239]
  v_cvt_pk_bf16_f32 v82, v116, v117
  v_mfma_f32_16x16x32_bf16 v[236:239], a[204:207], v[92:95], v[236:239]
  v_exp_f32_e32 v118, v118
  v_mfma_f32_16x16x32_bf16 v[240:243], a[208:211], v[92:95], v[240:243]
  s_waitcnt lgkmcnt(0)
  v_cmp_gt_u32 vcc, v22, v23
  v_mfma_f32_16x16x32_bf16 v[240:243], a[112:115], v[88:91], v[240:243]
  v_exp_f32_e32 v119, v119
  v_mfma_f32_16x16x32_bf16 v[244:247], a[116:119], v[88:91], v[244:247]
  v_cvt_pk_bf16_f32 v83, v118, v119
  v_mfma_f32_16x16x32_bf16 v[244:247], a[212:215], v[92:95], v[244:247]
  v_exp_f32_e32 v120, v120
  v_mfma_f32_16x16x32_bf16 v[248:251], a[216:219], v[92:95], v[248:251]
  s_cbranch_vccnz L_wait0
L_go0:
  v_mfma_f32_16x16x32_bf16 v[248:251], a[120:123], v[88:91], v[248:251]
  v_exp_f32_e32 v121, v121
  v_mfma_f32_16x16x32_bf16 v[252:255], a[124:127], v[88:91], v[252:255]
  v_cvt_pk_bf16_f32 v88, v120, v121
  v_mfma_f32_16x16x32_bf16 v[252:255], a[220:223], v[92:95], v[252:255]
  v_exp_f32_e32 v122, v122
  v_mfma_f32_16x16x32_bf16 v[96:99], a[64:67], a[0:3], v[48:51]
  ds_read_b64_tr_b16 a[96:97], v36 offset:16384
  ds_read_b64_tr_b16 a[98:99], v36 offset:20480
  v_mfma_f32_16x16x32_bf16 v[96:99], a[68:71], a[4:7], v[96:99]
  v_exp_f32_e32 v123, v123
  v_mfma_f32_16x16x32_bf16 v[96:99], a[72:75], a[8:11], v[96:99]
  ds_read_b64_tr_b16 a[192:193], v36 offset:24576
  v_cvt_pk_bf16_f32 v89, v122, v123
  v_mfma_f32_16x16x32_bf16 v[96:99], a[76:79], a[12:15], v[96:99]
  v_exp_f32_e32 v124, v124
  v_mfma_f32_16x16x32_bf16 v[100:103], a[92:95], a[12:15], v[48:51]
  ds_read_b64_tr_b16 a[194:195], v36 offset:28672
  ds_read_b64_tr_b16 a[100:101], v37 offset:16384
  v_mfma_f32_16x16x32_bf16 v[100:103], a[88:91], a[8:11], v[100:103]
  v_exp_f32_e32 v125, v125
  v_mfma_f32_16x16x32_bf16 v[100:103], a[84:87], a[4:7], v[100:103]
  ds_read_b64_tr_b16 a[102:103], v37 offset:20480
  v_cvt_pk_bf16_f32 v90, v124, v125
  v_mfma_f32_16x16x32_bf16 v[100:103], a[80:83], a[0:3], v[100:103]
  v_exp_f32_e32 v126, v126
  v_mfma_f32_16x16x32_bf16 v[108:111], a[80:83], a[16:19], v[52:55]
  ds_read_b64_tr_b16 a[196:197], v37 offset:24576
  ds_read_b64_tr_b16 a[198:199], v37 offset:28672
  v_mfma_f32_16x16x32_bf16 v[108:111], a[84:87], a[20:23], v[108:111]
  v_exp_f32_e32 v127, v127
  v_mfma_f32_16x16x32_bf16 v[108:111], a[88:91], a[24:27], v[108:111]
  ds_read_b64_tr_b16 a[104:105], v38 offset:16384
  v_cvt_pk_bf16_f32 v91, v126, v127
  v_mfma_f32_16x16x32_bf16 v[108:111], a[92:95], a[28:31], v[108:111]
  ds_read_b64_tr_b16 a[106:107], v38 offset:20480
  ds_read_b64_tr_b16 a[200:201], v38 offset:24576
  v_mfma_f32_16x16x32_bf16 v[104:107], a[76:79], a[28:31], v[52:55]
  ds_read_b64_tr_b16 a[202:203], v38 offset:28672
  ds_read_b64_tr_b16 a[108:109], v39 offset:16384
  v_mfma_f32_16x16x32_bf16 v[104:107], a[72:75], a[24:27], v[104:107]
  v_exp_f32_e32 v96, v96
  v_mfma_f32_16x16x32_bf16 v[104:107], a[68:71], a[20:23], v[104:107]
  ds_read_b64_tr_b16 a[110:111], v39 offset:20480
  ds_read_b64_tr_b16 a[204:205], v39 offset:24576
  v_mfma_f32_16x16x32_bf16 v[104:107], a[64:67], a[16:19], v[104:107]
  v_exp_f32_e32 v97, v97
  v_mfma_f32_16x16x32_bf16 v[112:115], a[64:67], a[32:35], v[56:59]
  ds_read_b64_tr_b16 a[206:207], v39 offset:28672
  v_cvt_pk_bf16_f32 v68, v96, v97
  v_mfma_f32_16x16x32_bf16 v[112:115], a[68:71], a[36:39], v[112:115]
  v_exp_f32_e32 v98, v98
  v_mfma_f32_16x16x32_bf16 v[112:115], a[72:75], a[40:43], v[112:115]
  ds_read_b64_tr_b16 a[112:113], v40 offset:16384
  ds_read_b64_tr_b16 a[114:115], v40 offset:20480
  v_mfma_f32_16x16x32_bf16 v[112:115], a[76:79], a[44:47], v[112:115]
  v_exp_f32_e32 v99, v99
  v_mfma_f32_16x16x32_bf16 v[116:119], a[92:95], a[44:47], v[56:59]
  ds_read_b64_tr_b16 a[208:209], v40 offset:24576
  v_cvt_pk_bf16_f32 v69, v98, v99
  v_mfma_f32_16x16x32_bf16 v[116:119], a[88:91], a[40:43], v[116:119]
  v_exp_f32_e32 v100, v100
  v_mfma_f32_16x16x32_bf16 v[116:119], a[84:87], a[36:39], v[116:119]
  ds_read_b64_tr_b16 a[210:211], v40 offset:28672
  ds_read_b64_tr_b16 a[116:117], v41 offset:16384
  v_mfma_f32_16x16x32_bf16 v[116:119], a[80:83], a[32:35], v[116:119]
  v_exp_f32_e32 v101, v101
  v_mfma_f32_16x16x32_bf16 v[124:127], a[80:83], a[48:51], v[60:63]
  ds_read_b64_tr_b16 a[118:119], v41 offset:20480
  v_cvt_pk_bf16_f32 v70, v100, v101
  v_mfma_f32_16x16x32_bf16 v[124:127], a[84:87], a[52:55], v[124:127]
  v_exp_f32_e32 v102, v102
  v_mfma_f32_16x16x32_bf16 v[124:127], a[88:91], a[56:59], v[124:127]
  ds_read_b64_tr_b16 a[212:213], v41 offset:24576
  ds_read_b64_tr_b16 a[214:215], v41 offset:28672
  v_mfma_f32_16x16x32_bf16 v[124:127], a[92:95], a[60:63], v[124:127]
  v_exp_f32_e32 v103, v103
  v_mfma_f32_16x16x32_bf16 v[120:123], a[76:79], a[60:63], v[60:63]
  ds_read_b64_tr_b16 a[120:121], v42 offset:16384
  v_cvt_pk_bf16_f32 v71, v102, v103
  v_mfma_f32_16x16x32_bf16 v[120:123], a[72:75], a[56:59], v[120:123]
  v_exp_f32_e32 v104, v104
  v_mfma_f32_16x16x32_bf16 v[120:123], a[68:71], a[52:55], v[120:123]
  ds_read_b64_tr_b16 a[122:123], v42 offset:20480
  s_waitcnt lgkmcnt(5)
  v_mfma_f32_16x16x32_bf16 v[120:123], a[64:67], a[48:51], v[120:123]
  v_exp_f32_e32 v105, v105
  v_mfma_f32_16x16x32_bf16 v[128:131], a[192:195], v[68:71], v[128:131]
  ds_read_b64_tr_b16 a[216:217], v42 offset:24576
  v_cvt_pk_bf16_f32 v76, v104, v105
  v_mfma_f32_16x16x32_bf16 v[128:131], a[96:99], v[64:67], v[128:131]
  v_exp_f32_e32 v106, v106
  v_mfma_f32_16x16x32_bf16 v[132:135], a[100:103], v[64:67], v[132:135]
  ds_read_b64_tr_b16 a[218:219], v42 offset:28672
  ds_read_b64_tr_b16 a[124:125], v43 offset:16384
  v_mfma_f32_16x16x32_bf16 v[132:135], a[196:199], v[68:71], v[132:135]
  v_exp_f32_e32 v107, v107
  v_mfma_f32_16x16x32_bf16 v[136:139], a[200:203], v[68:71], v[136:139]
  ds_read_b64_tr_b16 a[126:127], v43 offset:20480
  v_cvt_pk_bf16_f32 v77, v106, v107
  v_mfma_f32_16x16x32_bf16 v[136:139], a[104:107], v[64:67], v[136:139]
  v_exp_f32_e32 v108, v108
  v_mfma_f32_16x16x32_bf16 v[140:143], a[108:111], v[64:67], v[140:143]
  ds_read_b64_tr_b16 a[220:221], v43 offset:24576
  ds_read_b64_tr_b16 a[222:223], v43 offset:28672
  v_mfma_f32_16x16x32_bf16 v[140:143], a[204:207], v[68:71], v[140:143]
  v_exp_f32_e32 v109, v109
  v_mfma_f32_16x16x32_bf16 v[144:147], a[208:211], v[68:71], v[144:147]
  s_waitcnt lgkmcnt(4)
  v_cvt_pk_bf16_f32 v78, v108, v109
  v_mfma_f32_16x16x32_bf16 v[144:147], a[112:115], v[64:67], v[144:147]
  v_exp_f32_e32 v110, v110
  v_mfma_f32_16x16x32_bf16 v[148:151], a[116:119], v[64:67], v[148:151]
  ds_read_b128 a[64:67], v32 offset:16384
  v_mfma_f32_16x16x32_bf16 v[148:151], a[212:215], v[68:71], v[148:151]
  v_exp_f32_e32 v111, v111
  v_mfma_f32_16x16x32_bf16 v[152:155], a[216:219], v[68:71], v[152:155]
  s_waitcnt lgkmcnt(1)
  v_cvt_pk_bf16_f32 v79, v110, v111
  v_mfma_f32_16x16x32_bf16 v[152:155], a[120:123], v[64:67], v[152:155]
  v_exp_f32_e32 v112, v112
  v_mfma_f32_16x16x32_bf16 v[156:159], a[124:127], v[64:67], v[156:159]
  ds_read_b128 a[68:71], v33 offset:16384
  ds_read_b128 a[72:75], v34 offset:16384
  v_mfma_f32_16x16x32_bf16 v[156:159], a[220:223], v[68:71], v[156:159]
  v_exp_f32_e32 v113, v113
  v_smfmac_f32_16x16x64_bf16 a[128:131], a[144:147], v[64:71], v29
  ds_read_b128 a[76:79], v35 offset:16384
  v_cvt_pk_bf16_f32 v84, v112, v113
  v_mfma_f32_16x16x32_bf16 v[160:163], a[192:195], v[76:79], v[160:163]
  v_exp_f32_e32 v114, v114
  v_mfma_f32_16x16x32_bf16 v[160:163], a[96:99], v[72:75], v[160:163]
  ds_read_b128 a[80:83], v32 offset:20480
  v_mfma_f32_16x16x32_bf16 v[164:167], a[100:103], v[72:75], v[164:167]
  v_exp_f32_e32 v115, v115
  v_mfma_f32_16x16x32_bf16 v[164:167], a[196:199], v[76:79], v[164:167]
  ds_read_b128 a[84:87], v33 offset:20480
  v_cvt_pk_bf16_f32 v85, v114, v115
  v_mfma_f32_16x16x32_bf16 v[168:171], a[200:203], v[76:79], v[168:171]
  v_exp_f32_e32 v116, v116
  v_mfma_f32_16x16x32_bf16 v[168:171], a[104:107], v[72:75], v[168:171]
  ds_read_b128 a[88:91], v34 offset:20480
  v_mfma_f32_16x16x32_bf16 v[172:175], a[108:111], v[72:75], v[172:175]
  v_exp_f32_e32 v117, v117
  v_mfma_f32_16x16x32_bf16 v[172:175], a[204:207], v[76:79], v[172:175]
  ds_read_b128 a[92:95], v35 offset:20480
  v_cvt_pk_bf16_f32 v86, v116, v117
  v_mfma_f32_16x16x32_bf16 v[176:179], a[208:211], v[76:79], v[176:179]
  v_exp_f32_e32 v118, v118
  v_mfma_f32_16x16x32_bf16 v[176:179], a[112:115], v[72:75], v[176:179]
  s_mov_b32 m0, s31
  v_add_u32 v22, 1, v22
  v_mfma_f32_16x16x32_bf16 v[180:183], a[116:119], v[72:75], v[180:183]
  v_exp_f32_e32 v119, v119
  v_mfma_f32_16x16x32_bf16 v[180:183], a[212:215], v[76:79], v[180:183]
  v_cvt_pk_bf16_f32 v87, v118, v119
  v_mfma_f32_16x16x32_bf16 v[184:187], a[216:219], v[76:79], v[184:187]
  v_exp_f32_e32 v120, v120
  v_mfma_f32_16x16x32_bf16 v[184:187], a[120:123], v[72:75], v[184:187]
  s_waitcnt vmcnt(0) lgkmcnt(0)
  ds_write_b32 v20, v22
  v_mfma_f32_16x16x32_bf16 v[188:191], a[124:127], v[72:75], v[188:191]
  v_exp_f32_e32 v121, v121
  v_mfma_f32_16x16x32_bf16 v[188:191], a[220:223], v[76:79], v[188:191]
  v_cvt_pk_bf16_f32 v92, v120, v121
  v_smfmac_f32_16x16x64_bf16 a[132:135], a[144:147], v[72:79], v29
  v_exp_f32_e32 v122, v122
  v_mfma_f32_16x16x32_bf16 v[96:99], a[64:67], a[0:3], v[48:51]
  buffer_load_dwordx4 v44, s[16:19], s37 offen offset:0 lds
  v_mfma_f32_16x16x32_bf16 v[96:99], a[68:71], a[4:7], v[96:99]
  v_exp_f32_e32 v123, v123
  v_mfma_f32_16x16x32_bf16 v[96:99], a[72:75], a[8:11], v[96:99]
  v_cvt_pk_bf16_f32 v93, v122, v123
  v_mfma_f32_16x16x32_bf16 v[96:99], a[76:79], a[12:15], v[96:99]
  v_exp_f32_e32 v124, v124
  v_mfma_f32_16x16x32_bf16 v[100:103], a[92:95], a[12:15], v[48:51]
  buffer_load_dwordx4 v45, s[16:19], s37 offen offset:1024 lds
  v_mfma_f32_16x16x32_bf16 v[100:103], a[88:91], a[8:11], v[100:103]
  v_exp_f32_e32 v125, v125
  v_mfma_f32_16x16x32_bf16 v[100:103], a[84:87], a[4:7], v[100:103]
  v_cvt_pk_bf16_f32 v94, v124, v125
  v_mfma_f32_16x16x32_bf16 v[100:103], a[80:83], a[0:3], v[100:103]
  v_exp_f32_e32 v126, v126
  v_mfma_f32_16x16x32_bf16 v[108:111], a[80:83], a[16:19], v[52:55]
  buffer_load_dwordx4 v46, s[16:19], s37 offen offset:2048 lds
  v_mfma_f32_16x16x32_bf16 v[108:111], a[84:87], a[20:23], v[108:111]
  v_exp_f32_e32 v127, v127
  v_mfma_f32_16x16x32_bf16 v[108:111], a[88:91], a[24:27], v[108:111]
  v_cvt_pk_bf16_f32 v95, v126, v127
  v_mfma_f32_16x16x32_bf16 v[108:111], a[92:95], a[28:31], v[108:111]
  buffer_load_dwordx4 v47, s[16:19], s37 offen offset:3072 lds
  v_mfma_f32_16x16x32_bf16 v[104:107], a[76:79], a[28:31], v[52:55]
  s_mov_b32 m0, s35
  v_mfma_f32_16x16x32_bf16 v[104:107], a[72:75], a[24:27], v[104:107]
  v_exp_f32_e32 v96, v96
  v_mfma_f32_16x16x32_bf16 v[104:107], a[68:71], a[20:23], v[104:107]
  buffer_load_dwordx4 v30, s[20:23], s36 offen offset:0 lds
  v_mfma_f32_16x16x32_bf16 v[104:107], a[64:67], a[16:19], v[104:107]
  v_exp_f32_e32 v97, v97
  v_mfma_f32_16x16x32_bf16 v[112:115], a[64:67], a[32:35], v[56:59]
  v_cvt_pk_bf16_f32 v64, v96, v97
  v_mfma_f32_16x16x32_bf16 v[112:115], a[68:71], a[36:39], v[112:115]
  v_exp_f32_e32 v98, v98
  v_mfma_f32_16x16x32_bf16 v[112:115], a[72:75], a[40:43], v[112:115]
  buffer_load_dwordx4 v31, s[20:23], s36 offen offset:1024 lds
  v_mfma_f32_16x16x32_bf16 v[112:115], a[76:79], a[44:47], v[112:115]
  v_exp_f32_e32 v99, v99
  v_mfma_f32_16x16x32_bf16 v[116:119], a[92:95], a[44:47], v[56:59]
  v_cvt_pk_bf16_f32 v65, v98, v99
  v_mfma_f32_16x16x32_bf16 v[116:119], a[88:91], a[40:43], v[116:119]
  v_exp_f32_e32 v100, v100
  v_mfma_f32_16x16x32_bf16 v[116:119], a[84:87], a[36:39], v[116:119]
  buffer_load_dwordx4 v30, s[20:23], s36 offen offset:2048 lds
  v_mfma_f32_16x16x32_bf16 v[116:119], a[80:83], a[32:35], v[116:119]
  v_exp_f32_e32 v101, v101
  v_mfma_f32_16x16x32_bf16 v[124:127], a[80:83], a[48:51], v[60:63]
  v_cvt_pk_bf16_f32 v66, v100, v101
  v_mfma_f32_16x16x32_bf16 v[124:127], a[84:87], a[52:55], v[124:127]
  v_exp_f32_e32 v102, v102
  v_mfma_f32_16x16x32_bf16 v[124:127], a[88:91], a[56:59], v[124:127]
  buffer_load_dwordx4 v31, s[20:23], s36 offen offset:3072 lds
  v_mfma_f32_16x16x32_bf16 v[124:127], a[92:95], a[60:63], v[124:127]
  v_exp_f32_e32 v103, v103
  v_mfma_f32_16x16x32_bf16 v[120:123], a[76:79], a[60:63], v[60:63]
  v_cvt_pk_bf16_f32 v67, v102, v103
  v_mfma_f32_16x16x32_bf16 v[120:123], a[72:75], a[56:59], v[120:123]
  v_exp_f32_e32 v104, v104
  v_mfma_f32_16x16x32_bf16 v[120:123], a[68:71], a[52:55], v[120:123]
  v_mfma_f32_16x16x32_bf16 v[120:123], a[64:67], a[48:51], v[120:123]
  v_exp_f32_e32 v105, v105
  v_smfmac_f32_16x16x64_bf16 a[136:139], a[144:147], v[80:87], v29
  v_cvt_pk_bf16_f32 v72, v104, v105
  v_mfma_f32_16x16x32_bf16 v[192:195], a[192:195], v[84:87], v[192:195]
  v_exp_f32_e32 v106, v106
  v_mfma_f32_16x16x32_bf16 v[192:195], a[96:99], v[80:83], v[192:195]
  ds_read_b128 a[64:67], v32 offset:24576
  v_mfma_f32_16x16x32_bf16 v[196:199], a[100:103], v[80:83], v[196:199]
  v_exp_f32_e32 v107, v107
  v_mfma_f32_16x16x32_bf16 v[196:199], a[196:199], v[84:87], v[196:199]
  ds_read_b128 a[68:71], v33 offset:24576
  v_cvt_pk_bf16_f32 v73, v106, v107
  v_mfma_f32_16x16x32_bf16 v[200:203], a[200:203], v[84:87], v[200:203]
  v_exp_f32_e32 v108, v108
  v_mfma_f32_16x16x32_bf16 v[200:203], a[104:107], v[80:83], v[200:203]
  ds_read_b128 a[72:75], v34 offset:24576
  v_mfma_f32_16x16x32_bf16 v[204:207], a[108:111], v[80:83], v[204:207]
  v_exp_f32_e32 v109, v109
  v_mfma_f32_16x16x32_bf16 v[204:207], a[204:207], v[84:87], v[204:207]
  ds_read_b128 a[76:79], v35 offset:24576
  v_cvt_pk_bf16_f32 v74, v108, v109
  v_mfma_f32_16x16x32_bf16 v[208:211], a[208:211], v[84:87], v[208:211]
  v_exp_f32_e32 v110, v110
  v_mfma_f32_16x16x32_bf16 v[208:211], a[112:115], v[80:83], v[208:211]
  ds_read_b128 a[80:83], v32 offset:28672
  v_mfma_f32_16x16x32_bf16 v[212:215], a[116:119], v[80:83], v[212:215]
  v_exp_f32_e32 v111, v111
  v_mfma_f32_16x16x32_bf16 v[212:215], a[212:215], v[84:87], v[212:215]
  ds_read_b128 a[84:87], v33 offset:28672
  v_cvt_pk_bf16_f32 v75, v110, v111
  v_mfma_f32_16x16x32_bf16 v[216:219], a[216:219], v[84:87], v[216:219]
  v_exp_f32_e32 v112, v112
  v_mfma_f32_16x16x32_bf16 v[216:219], a[120:123], v[80:83], v[216:219]
  ds_read_b128 a[88:91], v34 offset:28672
  v_mfma_f32_16x16x32_bf16 v[220:223], a[124:127], v[80:83], v[220:223]
  v_exp_f32_e32 v113, v113
  v_mfma_f32_16x16x32_bf16 v[220:223], a[220:223], v[84:87], v[220:223]
  ds_read_b128 a[92:95], v35 offset:28672
  v_cvt_pk_bf16_f32 v80, v112, v113
  v_smfmac_f32_16x16x64_bf16 a[140:143], a[144:147], v[88:95], v29
  v_exp_f32_e32 v114, v114
  v_mfma_f32_16x16x32_bf16 v[224:227], a[192:195], v[92:95], v[224:227]
  ds_read_b32 v23, v21
  v_mfma_f32_16x16x32_bf16 v[224:227], a[96:99], v[88:91], v[224:227]
  v_exp_f32_e32 v115, v115
  v_mfma_f32_16x16x32_bf16 v[228:231], a[100:103], v[88:91], v[228:231]
  v_cvt_pk_bf16_f32 v81, v114, v115
  v_mfma_f32_16x16x32_bf16 v[228:231], a[196:199], v[92:95], v[228:231]
  v_exp_f32_e32 v116, v116
  v_mfma_f32_16x16x32_bf16 v[232:235], a[200:203], v[92:95], v[232:235]
  s_add_u32 s36, s37, 0x4000
  s_bitset0_b32 s36, 19
  v_mfma_f32_16x16x32_bf16 v[232:235], a[104:107], v[88:91], v[232:235]
  v_exp_f32_e32 v117, v117
  v_mfma_f32_16x16x32_bf16 v[236:239], a[108:111], v[88:91], v[236:239]
  v_cvt_pk_bf16_f32 v82, v116, v117
  v_mfma_f32_16x16x32_bf16 v[236:239], a[204:207], v[92:95], v[236:239]
  v_exp_f32_e32 v118, v118
  v_mfma_f32_16x16x32_bf16 v[240:243], a[208:211], v[92:95], v[240:243]
  s_waitcnt lgkmcnt(0)
  v_cmp_gt_u32 vcc, v22, v23
  v_mfma_f32_16x16x32_bf16 v[240:243], a[112:115], v[88:91], v[240:243]
  v_exp_f32_e32 v119, v119
  v_mfma_f32_16x16x32_bf16 v[244:247], a[116:119], v[88:91], v[244:247]
  v_cvt_pk_bf16_f32 v83, v118, v119
  v_mfma_f32_16x16x32_bf16 v[244:247], a[212:215], v[92:95], v[244:247]
  v_exp_f32_e32 v120, v120
  v_mfma_f32_16x16x32_bf16 v[248:251], a[216:219], v[92:95], v[248:251]
  s_cbranch_vccnz L_wait1
L_go1:
  v_mfma_f32_16x16x32_bf16 v[248:251], a[120:123], v[88:91], v[248:251]
  v_exp_f32_e32 v121, v121
  v_mfma_f32_16x16x32_bf16 v[252:255], a[124:127], v[88:91], v[252:255]
  v_cvt_pk_bf16_f32 v88, v120, v121
  v_mfma_f32_16x16x32_bf16 v[252:255], a[220:223], v[92:95], v[252:255]
  v_exp_f32_e32 v122, v122
  v_mfma_f32_16x16x32_bf16 v[96:99], a[64:67], a[0:3], v[48:51]
  ds_read_b64_tr_b16 a[96:97], v36 offset:32768
  ds_read_b64_tr_b16 a[98:99], v36 offset:36864
  v_mfma_f32_16x16x32_bf16 v[96:99], a[68:71], a[4:7], v[96:99]
  v_exp_f32_e32 v123, v123
  v_mfma_f32_16x16x32_bf16 v[96:99], a[72:75], a[8:11], v[96:99]
  ds_read_b64_tr_b16 a[192:193], v36 offset:40960
  v_cvt_pk_bf16_f32 v89, v122, v123
  v_mfma_f32_16x16x32_bf16 v[96:99], a[76:79], a[12:15], v[96:99]
  v_exp_f32_e32 v124, v124
  v_mfma_f32_16x16x32_bf16 v[100:103], a[92:95], a[12:15], v[48:51]
  ds_read_b64_tr_b16 a[194:195], v36 offset:45056
  ds_read_b64_tr_b16 a[100:101], v37 offset:32768
  v_mfma_f32_16x16x32_bf16 v[100:103], a[88:91], a[8:11], v[100:103]
  v_exp_f32_e32 v125, v125
  v_mfma_f32_16x16x32_bf16 v[100:103], a[84:87], a[4:7], v[100:103]
  ds_read_b64_tr_b16 a[102:103], v37 offset:36864
  v_cvt_pk_bf16_f32 v90, v124, v125
  v_mfma_f32_16x16x32_bf16 v[100:103], a[80:83], a[0:3], v[100:103]
  v_exp_f32_e32 v126, v126
  v_mfma_f32_16x16x32_bf16 v[108:111], a[80:83], a[16:19], v[52:55]
  ds_read_b64_tr_b16 a[196:197], v37 offset:40960
  ds_read_b64_tr_b16 a[198:199], v37 offset:45056
  v_mfma_f32_16x16x32_bf16 v[108:111], a[84:87], a[20:23], v[108:111]
  v_exp_f32_e32 v127, v127
  v_mfma_f32_16x16x32_bf16 v[108:111], a[88:91], a[24:27], v[108:111]
  ds_read_b64_tr_b16 a[104:105], v38 offset:32768
  v_cvt_pk_bf16_f32 v91, v126, v127
  v_mfma_f32_16x16x32_bf16 v[108:111], a[92:95], a[28:31], v[108:111]
  ds_read_b64_tr_b16 a[106:107], v38 offset:36864
  ds_read_b64_tr_b16 a[200:201], v38 offset:40960
  v_mfma_f32_16x16x32_bf16 v[104:107], a[76:79], a[28:31], v[52:55]
  ds_read_b64_tr_b16 a[202:203], v38 offset:45056
  ds_read_b64_tr_b16 a[108:109], v39 offset:32768
  v_mfma_f32_16x16x32_bf16 v[104:107], a[72:75], a[24:27], v[104:107]
  v_exp_f32_e32 v96, v96
  v_mfma_f32_16x16x32_bf16 v[104:107], a[68:71], a[20:23], v[104:107]
  ds_read_b64_tr_b16 a[110:111], v39 offset:36864
  ds_read_b64_tr_b16 a[204:205], v39 offset:40960
  v_mfma_f32_16x16x32_bf16 v[104:107], a[64:67], a[16:19], v[104:107]
  v_exp_f32_e32 v97, v97
  v_mfma_f32_16x16x32_bf16 v[112:115], a[64:67], a[32:35], v[56:59]
  ds_read_b64_tr_b16 a[206:207], v39 offset:45056
  v_cvt_pk_bf16_f32 v68, v96, v97
  v_mfma_f32_16x16x32_bf16 v[112:115], a[68:71], a[36:39], v[112:115]
  v_exp_f32_e32 v98, v98
  v_mfma_f32_16x16x32_bf16 v[112:115], a[72:75], a[40:43], v[112:115]
  ds_read_b64_tr_b16 a[112:113], v40 offset:32768
  ds_read_b64_tr_b16 a[114:115], v40 offset:36864
  v_mfma_f32_16x16x32_bf16 v[112:115], a[76:79], a[44:47], v[112:115]
  v_exp_f32_e32 v99, v99
  v_mfma_f32_16x16x32_bf16 v[116:119], a[92:95], a[44:47], v[56:59]
  ds_read_b64_tr_b16 a[208:209], v40 offset:40960
  v_cvt_pk_bf16_f32 v69, v98, v99
  v_mfma_f32_16x16x32_bf16 v[116:119], a[88:91], a[40:43], v[116:119]
  v_exp_f32_e32 v100, v100
  v_mfma_f32_16x16x32_bf16 v[116:119], a[84:87], a[36:39], v[116:119]
  ds_read_b64_tr_b16 a[210:211], v40 offset:45056
  ds_read_b64_tr_b16 a[116:117], v41 offset:32768
  v_mfma_f32_16x16x32_bf16 v[116:119], a[80:83], a[32:35], v[116:119]
  v_exp_f32_e32 v101, v101
  v_mfma_f32_16x16x32_bf16 v[124:127], a[80:83], a[48:51], v[60:63]
  ds_read_b64_tr_b16 a[118:119], v41 offset:36864
  v_cvt_pk_bf16_f32 v70, v100, v101
  v_mfma_f32_16x16x32_bf16 v[124:127], a[84:87], a[52:55], v[124:127]
  v_exp_f32_e32 v102, v102
  v_mfma_f32_16x16x32_bf16 v[124:127], a[88:91], a[56:59], v[124:127]
  ds_read_b64_tr_b16 a[212:213], v41 offset:40960
  ds_read_b64_tr_b16 a[214:215], v41 offset:45056
  v_mfma_f32_16x16x32_bf16 v[124:127], a[92:95], a[60:63], v[124:127]
  v_exp_f32_e32 v103, v103
  v_mfma_f32_16x16x32_bf16 v[120:123], a[76:79], a[60:63], v[60:63]
  ds_read_b64_tr_b16 a[120:121], v42 offset:32768
  v_cvt_pk_bf16_f32 v71, v102, v103
  v_mfma_f32_16x16x32_bf16 v[120:123], a[72:75], a[56:59], v[120:123]
  v_exp_f32_e32 v104, v104
  v_mfma_f32_16x16x32_bf16 v[120:123], a[68:71], a[52:55], v[120:123]
  ds_read_b64_tr_b16 a[122:123], v42 offset:36864
  s_waitcnt lgkmcnt(5)
  v_mfma_f32_16x16x32_bf16 v[120:123], a[64:67], a[48:51], v[120:123]
  v_exp_f32_e32 v105, v105
  v_mfma_f32_16x16x32_bf16 v[128:131], a[192:195], v[68:71], v[128:131]
  ds_read_b64_tr_b16 a[216:217], v42 offset:40960
  v_cvt_pk_bf16_f32 v76, v104, v105
  v_mfma_f32_16x16x32_bf16 v[128:131], a[96:99], v[64:67], v[128:131]
  v_exp_f32_e32 v106, v106
  v_mfma_f32_16x16x32_bf16 v[132:135], a[100:103], v[64:67], v[132:135]
  ds_read_b64_tr_b16 a[218:219], v42 offset:45056
  ds_read_b64_tr_b16 a[124:125], v43 offset:32768
  v_mfma_f32_16x16x32_bf16 v[132:135], a[196:199], v[68:71], v[132:135]
  v_exp_f32_e32 v107, v107
  v_mfma_f32_16x16x32_bf16 v[136:139], a[200:203], v[68:71], v[136:139]
  ds_read_b64_tr_b16 a[126:127], v43 offset:36864
  v_cvt_pk_bf16_f32 v77, v106, v107
  v_mfma_f32_16x16x32_bf16 v[136:139], a[104:107], v[64:67], v[136:139]
  v_exp_f32_e32 v108, v108
  v_mfma_f32_16x16x32_bf16 v[140:143], a[108:111], v[64:67], v[140:143]
  ds_read_b64_tr_b16 a[220:221], v43 offset:40960
  ds_read_b64_tr_b16 a[222:223], v43 offset:45056
  v_mfma_f32_16x16x32_bf16 v[140:143], a[204:207], v[68:71], v[140:143]
  v_exp_f32_e32 v109, v109
  v_mfma_f32_16x16x32_bf16 v[144:147], a[208:211], v[68:71], v[144:147]
  s_waitcnt lgkmcnt(4)
  v_cvt_pk_bf16_f32 v78, v108, v109
  v_mfma_f32_16x16x32_bf16 v[144:147], a[112:115], v[64:67], v[144:147]
  v_exp_f32_e32 v110, v110
  v_mfma_f32_16x16x32_bf16 v[148:151], a[116:119], v[64:67], v[148:151]
  ds_read_b128 a[64:67], v32 offset:32768
  v_mfma_f32_16x16x32_bf16 v[148:151], a[212:215], v[68:71], v[148:151]
  v_exp_f32_e32 v111, v111
  v_mfma_f32_16x16x32_bf16 v[152:155], a[216:219], v[68:71], v[152:155]
  s_waitcnt lgkmcnt(1)
  v_cvt_pk_bf16_f32 v79, v110, v111
  v_mfma_f32_16x16x32_bf16 v[152:155], a[120:123], v[64:67], v[152:155]
  v_exp_f32_e32 v112, v112
  v_mfma_f32_16x16x32_bf16 v[156:159], a[124:127], v[64:67], v[156:159]
  ds_read_b128 a[68:71], v33 offset:32768
  ds_read_b128 a[72:75], v34 offset:32768
  v_mfma_f32_16x16x32_bf16 v[156:159], a[220:223], v[68:71], v[156:159]
  v_exp_f32_e32 v113, v113
  v_smfmac_f32_16x16x64_bf16 a[128:131], a[144:147], v[64:71], v29
  ds_read_b128 a[76:79], v35 offset:32768
  v_cvt_pk_bf16_f32 v84, v112, v113
  v_mfma_f32_16x16x32_bf16 v[160:163], a[192:195], v[76:79], v[160:163]
  v_exp_f32_e32 v114, v114
  v_mfma_f32_16x16x32_bf16 v[160:163], a[96:99], v[72:75], v[160:163]
  ds_read_b128 a[80:83], v32 offset:36864
  v_mfma_f32_16x16x32_bf16 v[164:167], a[100:103], v[72:75], v[164:167]
  v_exp_f32_e32 v115, v115
  v_mfma_f32_16x16x32_bf16 v[164:167], a[196:199], v[76:79], v[164:167]
  ds_read_b128 a[84:87], v33 offset:36864
  v_cvt_pk_bf16_f32 v85, v114, v115
  v_mfma_f32_16x16x32_bf16 v[168:171], a[200:203], v[76:79], v[168:171]
  v_exp_f32_e32 v116, v116
  v_mfma_f32_16x16x32_bf16 v[168:171], a[104:107], v[72:75], v[168:171]
  ds_read_b128 a[88:91], v34 offset:36864
  v_mfma_f32_16x16x32_bf16 v[172:175], a[108:111], v[72:75], v[172:175]
  v_exp_f32_e32 v117, v117
  v_mfma_f32_16x16x32_bf16 v[172:175], a[204:207], v[76:79], v[172:175]
  ds_read_b128 a[92:95], v35 offset:36864
  v_cvt_pk_bf16_f32 v86, v116, v117
  v_mfma_f32_16x16x32_bf16 v[176:179], a[208:211], v[76:79], v[176:179]
  v_exp_f32_e32 v118, v118
  v_mfma_f32_16x16x32_bf16 v[176:179], a[112:115], v[72:75], v[176:179]
  s_mov_b32 m0, s28
  v_add_u32 v22, 1, v22
  v_mfma_f32_16x16x32_bf16 v[180:183], a[116:119], v[72:75], v[180:183]
  v_exp_f32_e32 v119, v119
  v_mfma_f32_16x16x32_bf16 v[180:183], a[212:215], v[76:79], v[180:183]
  v_cvt_pk_bf16_f32 v87, v118, v119
  v_mfma_f32_16x16x32_bf16 v[184:187], a[216:219], v[76:79], v[184:187]
  v_exp_f32_e32 v120, v120
  v_mfma_f32_16x16x32_bf16 v[184:187], a[120:123], v[72:75], v[184:187]
  s_waitcnt vmcnt(0) lgkmcnt(0)
  ds_write_b32 v20, v22
  v_mfma_f32_16x16x32_bf16 v[188:191], a[124:127], v[72:75], v[188:191]
  v_exp_f32_e32 v121, v121
  v_mfma_f32_16x16x32_bf16 v[188:191], a[220:223], v[76:79], v[188:191]
  v_cvt_pk_bf16_f32 v92, v120, v121
  v_smfmac_f32_16x16x64_bf16 a[132:135], a[144:147], v[72:79], v29
  v_exp_f32_e32 v122, v122
  v_mfma_f32_16x16x32_bf16 v[96:99], a[64:67], a[0:3], v[48:51]
  buffer_load_dwordx4 v44, s[16:19], s36 offen offset:0 lds
  v_mfma_f32_16x16x32_bf16 v[96:99], a[68:71], a[4:7], v[96:99]
  v_exp_f32_e32 v123, v123
  v_mfma_f32_16x16x32_bf16 v[96:99], a[72:75], a[8:11], v[96:99]
  v_cvt_pk_bf16_f32 v93, v122, v123
  v_mfma_f32_16x16x32_bf16 v[96:99], a[76:79], a[12:15], v[96:99]
  v_exp_f32_e32 v124, v124
  v_mfma_f32_16x16x32_bf16 v[100:103], a[92:95], a[12:15], v[48:51]
  buffer_load_dwordx4 v45, s[16:19], s36 offen offset:1024 lds
  v_mfma_f32_16x16x32_bf16 v[100:103], a[88:91], a[8:11], v[100:103]
  v_exp_f32_e32 v125, v125
  v_mfma_f32_16x16x32_bf16 v[100:103], a[84:87], a[4:7], v[100:103]
  v_cvt_pk_bf16_f32 v94, v124, v125
  v_mfma_f32_16x16x32_bf16 v[100:103], a[80:83], a[0:3], v[100:103]
  v_exp_f32_e32 v126, v126
  v_mfma_f32_16x16x32_bf16 v[108:111], a[80:83], a[16:19], v[52:55]
  buffer_load_dwordx4 v46, s[16:19], s36 offen offset:2048 lds
  v_mfma_f32_16x16x32_bf16 v[108:111], a[84:87], a[20:23], v[108:111]
  v_exp_f32_e32 v127, v127
  v_mfma_f32_16x16x32_bf16 v[108:111], a[88:91], a[24:27], v[108:111]
  v_cvt_pk_bf16_f32 v95, v126, v127
  v_mfma_f32_16x16x32_bf16 v[108:111], a[92:95], a[28:31], v[108:111]
  buffer_load_dwordx4 v47, s[16:19], s36 offen offset:3072 lds
  v_mfma_f32_16x16x32_bf16 v[104:107], a[76:79], a[28:31], v[52:55]
  s_mov_b32 m0, s32
  v_mfma_f32_16x16x32_bf16 v[104:107], a[72:75], a[24:27], v[104:107]
  v_exp_f32_e32 v96, v96
  v_mfma_f32_16x16x32_bf16 v[104:107], a[68:71], a[20:23], v[104:107]
  buffer_load_dwordx4 v30, s[20:23], s37 offen offset:0 lds
  v_mfma_f32_16x16x32_bf16 v[104:107], a[64:67], a[16:19], v[104:107]
  v_exp_f32_e32 v97, v97
  v_mfma_f32_16x16x32_bf16 v[112:115], a[64:67], a[32:35], v[56:59]
  v_cvt_pk_bf16_f32 v64, v96, v97
  v_mfma_f32_16x16x32_bf16 v[112:115], a[68:71], a[36:39], v[112:115]
  v_exp_f32_e32 v98, v98
  v_mfma_f32_16x16x32_bf16 v[112:115], a[72:75], a[40:43], v[112:115]
  buffer_load_dwordx4 v31, s[20:23], s37 offen offset:1024 lds
  v_mfma_f32_16x16x32_bf16 v[112:115], a[76:79], a[44:47], v[112:115]
  v_exp_f32_e32 v99, v99
  v_mfma_f32_16x16x32_bf16 v[116:119], a[92:95], a[44:47], v[56:59]
  v_cvt_pk_bf16_f32 v65, v98, v99
  v_mfma_f32_16x16x32_bf16 v[116:119], a[88:91], a[40:43], v[116:119]
  v_exp_f32_e32 v100, v100
  v_mfma_f32_16x16x32_bf16 v[116:119], a[84:87], a[36:39], v[116:119]
  buffer_load_dwordx4 v30, s[20:23], s37 offen offset:2048 lds
  v_mfma_f32_16x16x32_bf16 v[116:119], a[80:83], a[32:35], v[116:119]
  v_exp_f32_e32 v101, v101
  v_mfma_f32_16x16x32_bf16 v[124:127], a[80:83], a[48:51], v[60:63]
  v_cvt_pk_bf16_f32 v66, v100, v101
  v_mfma_f32_16x16x32_bf16 v[124:127], a[84:87], a[52:55], v[124:127]
  v_exp_f32_e32 v102, v102
  v_mfma_f32_16x16x32_bf16 v[124:127], a[88:91], a[56:59], v[124:127]
  buffer_load_dwordx4 v31, s[20:23], s37 offen offset:3072 lds
  v_mfma_f32_16x16x32_bf16 v[124:127], a[92:95], a[60:63], v[124:127]
  v_exp_f32_e32 v103, v103
  v_mfma_f32_16x16x32_bf16 v[120:123], a[76:79], a[60:63], v[60:63]
  v_cvt_pk_bf16_f32 v67, v102, v103
  v_mfma_f32_16x16x32_bf16 v[120:123], a[72:75], a[56:59], v[120:123]
  v_exp_f32_e32 v104, v104
  v_mfma_f32_16x16x32_bf16 v[120:123], a[68:71], a[52:55], v[120:123]
  s_add_u32 s39, s39, 1
  v_mfma_f32_16x16x32_bf16 v[120:123], a[64:67], a[48:51], v[120:123]
  v_exp_f32_e32 v105, v105
  v_smfmac_f32_16x16x64_bf16 a[136:139], a[144:147], v[80:87], v29
  v_cvt_pk_bf16_f32 v72, v104, v105
  v_mfma_f32_16x16x32_bf16 v[192:195], a[192:195], v[84:87], v[192:195]
  v_exp_f32_e32 v106, v106
  v_mfma_f32_16x16x32_bf16 v[192:195], a[96:99], v[80:83], v[192:195]
  ds_read_b128 a[64:67], v32 offset:40960
  v_mfma_f32_16x16x32_bf16 v[196:199], a[100:103], v[80:83], v[196:199]
  v_exp_f32_e32 v107, v107
  v_mfma_f32_16x16x32_bf16 v[196:199], a[196:199], v[84:87], v[196:199]
  ds_read_b128 a[68:71], v33 offset:40960
  v_cvt_pk_bf16_f32 v73, v106, v107
  v_mfma_f32_16x16x32_bf16 v[200:203], a[200:203], v[84:87], v[200:203]
  v_exp_f32_e32 v108, v108
  v_mfma_f32_16x16x32_bf16 v[200:203], a[104:107], v[80:83], v[200:203]
  ds_read_b128 a[72:75], v34 offset:40960
  v_mfma_f32_16x16x32_bf16 v[204:207], a[108:111], v[80:83], v[204:207]
  v_exp_f32_e32 v109, v109
  v_mfma_f32_16x16x32_bf16 v[204:207], a[204:207], v[84:87], v[204:207]
  ds_read_b128 a[76:79], v35 offset:40960
  v_cvt_pk_bf16_f32 v74, v108, v109
  v_mfma_f32_16x16x32_bf16 v[208:211], a[208:211], v[84:87], v[208:211]
  v_exp_f32_e32 v110, v110
  v_mfma_f32_16x16x32_bf16 v[208:211], a[112:115], v[80:83], v[208:211]
  ds_read_b128 a[80:83], v32 offset:45056
  v_mfma_f32_16x16x32_bf16 v[212:215], a[116:119], v[80:83], v[212:215]
  v_exp_f32_e32 v111, v111
  v_mfma_f32_16x16x32_bf16 v[212:215], a[212:215], v[84:87], v[212:215]
  ds_read_b128 a[84:87], v33 offset:45056
  v_cvt_pk_bf16_f32 v75, v110, v111
  v_mfma_f32_16x16x32_bf16 v[216:219], a[216:219], v[84:87], v[216:219]
  v_exp_f32_e32 v112, v112
  v_mfma_f32_16x16x32_bf16 v[216:219], a[120:123], v[80:83], v[216:219]
  ds_read_b128 a[88:91], v34 offset:45056
  v_mfma_f32_16x16x32_bf16 v[220:223], a[124:127], v[80:83], v[220:223]
  v_exp_f32_e32 v113, v113
  v_mfma_f32_16x16x32_bf16 v[220:223], a[220:223], v[84:87], v[220:223]
  ds_read_b128 a[92:95], v35 offset:45056
  v_cvt_pk_bf16_f32 v80, v112, v113
  v_smfmac_f32_16x16x64_bf16 a[140:143], a[144:147], v[88:95], v29
  v_exp_f32_e32 v114, v114
  v_mfma_f32_16x16x32_bf16 v[224:227], a[192:195], v[92:95], v[224:227]
  ds_read_b32 v23, v21
  v_mfma_f32_16x16x32_bf16 v[224:227], a[96:99], v[88:91], v[224:227]
  v_exp_f32_e32 v115, v115
  v_mfma_f32_16x16x32_bf16 v[228:231], a[100:103], v[88:91], v[228:231]
  v_cvt_pk_bf16_f32 v81, v114, v115
  v_mfma_f32_16x16x32_bf16 v[228:231], a[196:199], v[92:95], v[228:231]
  v_exp_f32_e32 v116, v116
  v_mfma_f32_16x16x32_bf16 v[232:235], a[200:203], v[92:95], v[232:235]
  s_add_u32 s37, s36, 0x4000
  s_bitset0_b32 s37, 19
  v_mfma_f32_16x16x32_bf16 v[232:235], a[104:107], v[88:91], v[232:235]
  v_exp_f32_e32 v117, v117
  v_mfma_f32_16x16x32_bf16 v[236:239], a[108:111], v[88:91], v[236:239]
  v_cvt_pk_bf16_f32 v82, v116, v117
  v_mfma_f32_16x16x32_bf16 v[236:239], a[204:207], v[92:95], v[236:239]
  v_exp_f32_e32 v118, v118
  v_mfma_f32_16x16x32_bf16 v[240:243], a[208:211], v[92:95], v[240:243]
  s_waitcnt lgkmcnt(0)
  v_cmp_gt_u32 vcc, v22, v23
  v_mfma_f32_16x16x32_bf16 v[240:243], a[112:115], v[88:91], v[240:243]
  v_exp_f32_e32 v119, v119
  v_mfma_f32_16x16x32_bf16 v[244:247], a[116:119], v[88:91], v[244:247]
  v_cvt_pk_bf16_f32 v83, v118, v119
  v_mfma_f32_16x16x32_bf16 v[244:247], a[212:215], v[92:95], v[244:247]
  v_exp_f32_e32 v120, v120
  v_mfma_f32_16x16x32_bf16 v[248:251], a[216:219], v[92:95], v[248:251]
  s_cmp_eq_u32 s39, 8
  s_cbranch_vccnz L_wait2
L_go2:
  v_mfma_f32_16x16x32_bf16 v[248:251], a[120:123], v[88:91], v[248:251]
  v_exp_f32_e32 v121, v121
  v_mfma_f32_16x16x32_bf16 v[252:255], a[124:127], v[88:91], v[252:255]
  v_cvt_pk_bf16_f32 v88, v120, v121
  v_mfma_f32_16x16x32_bf16 v[252:255], a[220:223], v[92:95], v[252:255]
  v_exp_f32_e32 v122, v122
  s_cbranch_scc0 L_loop
L_tail:
  v_mfma_f32_16x16x32_bf16 v[96:99], a[64:67], a[0:3], v[48:51]
  v_exp_f32_e32 v123, v123
  v_mfma_f32_16x16x32_bf16 v[96:99], a[68:71], a[4:7], v[96:99]
  ds_read_b64_tr_b16 a[192:193], v36 offset:57344
  v_cvt_pk_bf16_f32 v89, v122, v123
  v_mfma_f32_16x16x32_bf16 v[96:99], a[72:75], a[8:11], v[96:99]
  ds_read_b64_tr_b16 a[194:195], v36 offset:61440
  ds_read_b64_tr_b16 a[96:97], v36 offset:49152
  v_mfma_f32_16x16x32_bf16 v[96:99], a[76:79], a[12:15], v[96:99]
  ds_read_b64_tr_b16 a[98:99], v36 offset:53248
  ds_read_b64_tr_b16 a[100:101], v37 offset:49152
  v_mfma_f32_16x16x32_bf16 v[100:103], a[80:83], a[0:3], v[48:51]
  ds_read_b64_tr_b16 a[102:103], v37 offset:53248
  ds_read_b64_tr_b16 a[196:197], v37 offset:57344
  v_mfma_f32_16x16x32_bf16 v[100:103], a[84:87], a[4:7], v[100:103]
  v_exp_f32_e32 v124, v124
  v_mfma_f32_16x16x32_bf16 v[100:103], a[88:91], a[8:11], v[100:103]
  v_exp_f32_e32 v125, v125
  v_mfma_f32_16x16x32_bf16 v[100:103], a[92:95], a[12:15], v[100:103]
  ds_read_b64_tr_b16 a[198:199], v37 offset:61440
  v_cvt_pk_bf16_f32 v90, v124, v125
  v_mfma_f32_16x16x32_bf16 v[104:107], a[64:67], a[16:19], v[52:55]
  v_exp_f32_e32 v126, v126
  v_mfma_f32_16x16x32_bf16 v[104:107], a[68:71], a[20:23], v[104:107]
  v_exp_f32_e32 v127, v127
  v_mfma_f32_16x16x32_bf16 v[104:107], a[72:75], a[24:27], v[104:107]
  ds_read_b64_tr_b16 a[200:201], v38 offset:57344
  v_cvt_pk_bf16_f32 v91, v126, v127
  v_mfma_f32_16x16x32_bf16 v[104:107], a[76:79], a[28:31], v[104:107]
  ds_read_b64_tr_b16 a[202:203], v38 offset:61440
  ds_read_b64_tr_b16 a[104:105], v38 offset:49152
  v_mfma_f32_16x16x32_bf16 v[108:111], a[80:83], a[16:19], v[52:55]
  ds_read_b64_tr_b16 a[106:107], v38 offset:53248
  ds_read_b64_tr_b16 a[108:109], v39 offset:49152
  v_mfma_f32_16x16x32_bf16 v[108:111], a[84:87], a[20:23], v[108:111]
  ds_read_b64_tr_b16 a[110:111], v39 offset:53248
  ds_read_b64_tr_b16 a[204:205], v39 offset:57344
  v_mfma_f32_16x16x32_bf16 v[108:111], a[88:91], a[24:27], v[108:111]
  ds_read_b64_tr_b16 a[206:207], v39 offset:61440
  ds_read_b64_tr_b16 a[208:209], v40 offset:57344
  v_mfma_f32_16x16x32_bf16 v[108:111], a[92:95], a[28:31], v[108:111]
  v_exp_f32_e32 v96, v96
  v_mfma_f32_16x16x32_bf16 v[112:115], a[64:67], a[32:35], v[56:59]
  v_exp_f32_e32 v97, v97
  v_mfma_f32_16x16x32_bf16 v[112:115], a[68:71], a[36:39], v[112:115]
  ds_read_b64_tr_b16 a[210:211], v40 offset:61440
  ds_read_b64_tr_b16 a[112:113], v40 offset:49152
  v_cvt_pk_bf16_f32 v68, v96, v97
  v_mfma_f32_16x16x32_bf16 v[112:115], a[72:75], a[40:43], v[112:115]
  ds_read_b64_tr_b16 a[114:115], v40 offset:53248
  v_exp_f32_e32 v98, v98
  v_mfma_f32_16x16x32_bf16 v[112:115], a[76:79], a[44:47], v[112:115]
  ds_read_b64_tr_b16 a[116:117], v41 offset:49152
  v_exp_f32_e32 v99, v99
  v_mfma_f32_16x16x32_bf16 v[116:119], a[80:83], a[32:35], v[56:59]
  ds_read_b64_tr_b16 a[118:119], v41 offset:53248
  ds_read_b64_tr_b16 a[212:213], v41 offset:57344
  v_cvt_pk_bf16_f32 v69, v98, v99
  v_mfma_f32_16x16x32_bf16 v[116:119], a[84:87], a[36:39], v[116:119]
  v_exp_f32_e32 v100, v100
  v_mfma_f32_16x16x32_bf16 v[116:119], a[88:91], a[40:43], v[116:119]
  v_exp_f32_e32 v101, v101
  v_mfma_f32_16x16x32_bf16 v[116:119], a[92:95], a[44:47], v[116:119]
  ds_read_b64_tr_b16 a[214:215], v41 offset:61440
  v_cvt_pk_bf16_f32 v70, v100, v101
  v_mfma_f32_16x16x32_bf16 v[120:123], a[64:67], a[48:51], v[60:63]
  ds_read_b64_tr_b16 a[216:217], v42 offset:57344
  ds_read_b64_tr_b16 a[218:219], v42 offset:61440
  v_exp_f32_e32 v102, v102
  v_mfma_f32_16x16x32_bf16 v[120:123], a[68:71], a[52:55], v[120:123]
  ds_read_b64_tr_b16 a[120:121], v42 offset:49152
  ds_read_b64_tr_b16 a[122:123], v42 offset:53248
  v_exp_f32_e32 v103, v103
  v_mfma_f32_16x16x32_bf16 v[120:123], a[72:75], a[56:59], v[120:123]
  ds_read_b64_tr_b16 a[124:125], v43 offset:49152
  ds_read_b64_tr_b16 a[126:127], v43 offset:53248
  ds_read_b64_tr_b16 a[220:221], v43 offset:57344
  v_cvt_pk_bf16_f32 v71, v102, v103
  v_mfma_f32_16x16x32_bf16 v[120:123], a[76:79], a[60:63], v[120:123]
  ds_read_b64_tr_b16 a[222:223], v43 offset:61440
  ds_read_b128 a[160:163], v32 offset:49152
  v_exp_f32_e32 v104, v104
  v_mfma_f32_16x16x32_bf16 v[124:127], a[80:83], a[48:51], v[60:63]
  ds_read_b128 a[164:167], v33 offset:49152
  ds_read_b128 a[168:171], v34 offset:49152
  v_exp_f32_e32 v105, v105
  v_mfma_f32_16x16x32_bf16 v[124:127], a[84:87], a[52:55], v[124:127]
  ds_read_b128 a[172:175], v35 offset:49152
  ds_read_b128 a[176:179], v32 offset:53248
  v_cvt_pk_bf16_f32 v76, v104, v105
  v_mfma_f32_16x16x32_bf16 v[124:127], a[88:91], a[56:59], v[124:127]
  ds_read_b128 a[180:183], v33 offset:53248
  v_exp_f32_e32 v106, v106
  v_mfma_f32_16x16x32_bf16 v[124:127], a[92:95], a[60:63], v[124:127]
  ds_read_b128 a[184:187], v34 offset:53248
  v_exp_f32_e32 v107, v107
  v_smfmac_f32_16x16x64_bf16 a[128:131], a[144:147], v[64:71], v29
  ds_read_b128 a[188:191], v35 offset:53248
  ds_read_b128 a[64:67], v32 offset:57344
  v_cvt_pk_bf16_f32 v77, v106, v107
  s_waitcnt lgkmcnt(15)
  v_mfma_f32_16x16x32_bf16 v[128:131], a[192:195], v[68:71], v[128:131]
  ds_read_b128 a[68:71], v33 offset:57344
  v_exp_f32_e32 v108, v108
  v_mfma_f32_16x16x32_bf16 v[128:131], a[96:99], v[64:67], v[128:131]
  ds_read_b128 a[72:75], v34 offset:57344
  ds_read_b128 a[76:79], v35 offset:57344
  v_accvgpr_read_b32 v8, a128
  v_mfma_f32_16x16x32_bf16 v[132:135], a[100:103], v[64:67], v[132:135]
  ds_read_b128 a[80:83], v32 offset:61440
  ds_read_b128 a[84:87], v33 offset:61440
  v_accvgpr_read_b32 v4, a129
  v_mfma_f32_16x16x32_bf16 v[132:135], a[196:199], v[68:71], v[132:135]
  ds_read_b128 a[88:91], v34 offset:61440
  ds_read_b128 a[92:95], v35 offset:61440
  v_add_f32 v8, v8, v4
  v_mfma_f32_16x16x32_bf16 v[136:139], a[200:203], v[68:71], v[136:139]
  v_rcp_f32 v12, v8
  v_cmp_nge_f32 vcc, s53, v8
  v_mfma_f32_16x16x32_bf16 v[136:139], a[104:107], v[64:67], v[136:139]
  s_or_b64 s[44:45], s[44:45], vcc
  v_mul_f32_e64 v48, -v3, v12
  v_fma_f32 v128, v128, v12, v48
  v_mfma_f32_16x16x32_bf16 v[140:143], a[108:111], v[64:67], v[140:143]
  v_exp_f32_e32 v109, v109
  v_fma_f32 v129, v129, v12, v48
  v_mfma_f32_16x16x32_bf16 v[140:143], a[204:207], v[68:71], v[140:143]
  v_cvt_pk_bf16_f32 v78, v108, v109
  v_exp_f32_e32 v110, v110
  v_exp_f32_e32 v111, v111
  v_fma_f32 v130, v130, v12, v48
  v_mfma_f32_16x16x32_bf16 v[144:147], a[208:211], v[68:71], v[144:147]
  v_cvt_pk_bf16_f32 v79, v110, v111
  v_fma_f32 v131, v131, v12, v48
  v_max3_f32 v50, |v128|, |v129|, |v130|
  v_cvt_pk_bf16_f32 v128, v128, v129
  v_cvt_pk_bf16_f32 v129, v130, v131
  v_fma_f32 v132, v132, v12, v48
  v_mfma_f32_16x16x32_bf16 v[144:147], a[112:115], v[64:67], v[144:147]
  ds_write_b64 v28, v[128:129] offset:0
  v_fma_f32 v133, v133, v12, v48
  v_fma_f32 v134, v134, v12, v48
  v_mfma_f32_16x16x32_bf16 v[148:151], a[116:119], v[64:67], v[148:151]
  v_fma_f32 v135, v135, v12, v48
  v_max3_f32 v50, v50, |v132|, |v133|
  v_max3_f32 v50, v50, |v134|, |v135|
  v_mul_f32 v50, 0x44800000, v50
  v_mfma_f32_16x16x32_bf16 v[148:151], a[212:215], v[68:71], v[148:151]
  v_cmp_nge_f32_e64 vcc, v50, |v48|
  s_or_b64 s[44:45], s[44:45], vcc
  v_cvt_pk_bf16_f32 v132, v132, v133
  v_cvt_pk_bf16_f32 v133, v134, v135
  v_fma_f32 v136, v136, v12, v48
  v_fma_f32 v137, v137, v12, v48
  v_mfma_f32_16x16x32_bf16 v[152:155], a[216:219], v[68:71], v[152:155]
  ds_write_b64 v28, v[132:133] offset:32
  v_fma_f32 v138, v138, v12, v48
  v_fma_f32 v139, v139, v12, v48
  v_cvt_pk_bf16_f32 v136, v136, v137
  v_cvt_pk_bf16_f32 v137, v138, v139
  s_waitcnt lgkmcnt(15)
  v_mfma_f32_16x16x32_bf16 v[152:155], a[120:123], v[64:67], v[152:155]
  ds_write_b64 v28, v[136:137] offset:64
  v_fma_f32 v140, v140, v12, v48
  v_fma_f32 v141, v141, v12, v48
  v_mfma_f32_16x16x32_bf16 v[156:159], a[124:127], v[64:67], v[156:159]
  v_fma_f32 v142, v142, v12, v48
  v_fma_f32 v143, v143, v12, v48
  v_cvt_pk_bf16_f32 v140, v140, v141
  v_cvt_pk_bf16_f32 v141, v142, v143
  v_mfma_f32_16x16x32_bf16 v[156:159], a[220:223], v[68:71], v[156:159]
  ds_write_b64 v28, v[140:141] offset:96
  ds_read_b128 v[132:135], v24 offset:0
  ds_read_b128 v[140:143], v24 offset:3200
  v_fma_f32 v144, v144, v12, v48
  v_fma_f32 v145, v145, v12, v48
  v_smfmac_f32_16x16x64_bf16 a[132:135], a[144:147], v[72:79], v29
  v_fma_f32 v146, v146, v12, v48
  v_fma_f32 v147, v147, v12, v48
  v_cvt_pk_bf16_f32 v144, v144, v145
  v_cvt_pk_bf16_f32 v145, v146, v147
  v_mfma_f32_16x16x32_bf16 v[160:163], a[192:195], v[76:79], v[160:163]
  ds_write_b64 v28, v[144:145] offset:128
  v_fma_f32 v148, v148, v12, v48
  v_fma_f32 v149, v149, v12, v48
  v_mfma_f32_16x16x32_bf16 v[160:163], a[96:99], v[72:75], v[160:163]
  v_fma_f32 v150, v150, v12, v48
  v_fma_f32 v151, v151, v12, v48
  v_cvt_pk_bf16_f32 v148, v148, v149
  v_mfma_f32_16x16x32_bf16 v[164:167], a[100:103], v[72:75], v[164:167]
  v_cvt_pk_bf16_f32 v149, v150, v151
  v_fma_f32 v152, v152, v12, v48
  v_fma_f32 v153, v153, v12, v48
  v_fma_f32 v154, v154, v12, v48
  v_fma_f32 v155, v155, v12, v48
  v_cvt_pk_bf16_f32 v152, v152, v153
  v_mfma_f32_16x16x32_bf16 v[164:167], a[196:199], v[76:79], v[164:167]
  ds_write_b64 v28, v[148:149] offset:160
  v_cvt_pk_bf16_f32 v153, v154, v155
  v_fma_f32 v156, v156, v12, v48
  v_mfma_f32_16x16x32_bf16 v[168:171], a[200:203], v[76:79], v[168:171]
  ds_write_b64 v28, v[152:153] offset:192
  v_fma_f32 v157, v157, v12, v48
  v_mfma_f32_16x16x32_bf16 v[168:171], a[104:107], v[72:75], v[168:171]
  v_fma_f32 v158, v158, v12, v48
  v_fma_f32 v159, v159, v12, v48
  v_mfma_f32_16x16x32_bf16 v[172:175], a[108:111], v[72:75], v[172:175]
  v_cvt_pk_bf16_f32 v156, v156, v157
  v_cvt_pk_bf16_f32 v157, v158, v159
  v_mfma_f32_16x16x32_bf16 v[172:175], a[204:207], v[76:79], v[172:175]
  ds_write_b64 v28, v[156:157] offset:224
  v_mfma_f32_16x16x32_bf16 v[176:179], a[208:211], v[76:79], v[176:179]
  ds_read_b128 v[148:151], v24 offset:128
  ds_read_b128 v[156:159], v24 offset:3328
  v_mfma_f32_16x16x32_bf16 v[176:179], a[112:115], v[72:75], v[176:179]
  v_exp_f32_e32 v112, v112
  v_mfma_f32_16x16x32_bf16 v[180:183], a[116:119], v[72:75], v[180:183]
  s_waitcnt lgkmcnt(7)
  buffer_store_dwordx4 v[132:135], v27, s[24:27], s40 offen offset:0 sc0 sc1
  s_mov_b32 s47, 0x4000
  v_mfma_f32_16x16x32_bf16 v[180:183], a[212:215], v[76:79], v[180:183]
  v_exp_f32_e32 v113, v113
  v_mfma_f32_16x16x32_bf16 v[184:187], a[216:219], v[76:79], v[184:187]
  s_waitcnt lgkmcnt(6)
  buffer_store_dwordx4 v[140:143], v27, s[24:27], s40 offen offset:2048 sc0 sc1
  v_cvt_pk_bf16_f32 v84, v112, v113
  v_mfma_f32_16x16x32_bf16 v[184:187], a[120:123], v[72:75], v[184:187]
  v_exp_f32_e32 v114, v114
  v_mfma_f32_16x16x32_bf16 v[188:191], a[124:127], v[72:75], v[188:191]
  v_exp_f32_e32 v115, v115
  v_mfma_f32_16x16x32_bf16 v[188:191], a[220:223], v[76:79], v[188:191]
  v_cvt_pk_bf16_f32 v85, v114, v115
  v_mov_b64 v[76:77], 0
  v_mfma_f32_16x16x32_bf16 v[104:107], a[160:163], a[16:19], v[52:55]
  v_exp_f32_e32 v116, v116
  v_mfma_f32_16x16x32_bf16 v[104:107], a[164:167], a[20:23], v[104:107]
  s_waitcnt lgkmcnt(1)
  buffer_store_dwordx4 v[148:151], v27, s[24:27], s40 offen offset:128 sc0 sc1
  s_waitcnt lgkmcnt(0)
  buffer_store_dwordx4 v[156:159], v27, s[24:27], s40 offen offset:2176 sc0 sc1
  v_mfma_f32_16x16x32_bf16 v[104:107], a[168:171], a[24:27], v[104:107]
  v_exp_f32_e32 v117, v117
  v_mfma_f32_16x16x32_bf16 v[104:107], a[172:175], a[28:31], v[104:107]
  v_cvt_pk_bf16_f32 v86, v116, v117
  v_mov_b64 v[78:79], 0
  v_mfma_f32_16x16x32_bf16 v[108:111], a[176:179], a[16:19], v[52:55]
  v_exp_f32_e32 v118, v118
  v_mfma_f32_16x16x32_bf16 v[108:111], a[180:183], a[20:23], v[108:111]
  v_exp_f32_e32 v119, v119
  v_mfma_f32_16x16x32_bf16 v[108:111], a[184:187], a[24:27], v[108:111]
  v_cvt_pk_bf16_f32 v87, v118, v119
  s_mov_b32 m0, s33
  v_mfma_f32_16x16x32_bf16 v[108:111], a[188:191], a[28:31], v[108:111]
  v_exp_f32_e32 v120, v120
  v_mfma_f32_16x16x32_bf16 v[112:115], a[160:163], a[32:35], v[56:59]
  v_exp_f32_e32 v121, v121
  v_mfma_f32_16x16x32_bf16 v[112:115], a[164:167], a[36:39], v[112:115]
  buffer_load_dwordx4 v30, s[20:23], s47 offen offset:0 lds
  v_cvt_pk_bf16_f32 v92, v120, v121
  v_mfma_f32_16x16x32_bf16 v[112:115], a[168:171], a[40:43], v[112:115]
  v_exp_f32_e32 v122, v122
  v_mfma_f32_16x16x32_bf16 v[112:115], a[172:175], a[44:47], v[112:115]
  v_exp_f32_e32 v123, v123
  v_mfma_f32_16x16x32_bf16 v[116:119], a[176:179], a[32:35], v[56:59]
  buffer_load_dwordx4 v31, s[20:23], s47 offen offset:1024 lds
  v_cvt_pk_bf16_f32 v93, v122, v123
  v_mfma_f32_16x16x32_bf16 v[116:119], a[180:183], a[36:39], v[116:119]
  v_exp_f32_e32 v124, v124
  v_mfma_f32_16x16x32_bf16 v[116:119], a[184:187], a[40:43], v[116:119]
  v_exp_f32_e32 v125, v125
  v_mfma_f32_16x16x32_bf16 v[116:119], a[188:191], a[44:47], v[116:119]
  buffer_load_dwordx4 v30, s[20:23], s47 offen offset:2048 lds
  v_cvt_pk_bf16_f32 v94, v124, v125
  v_mfma_f32_16x16x32_bf16 v[120:123], a[160:163], a[48:51], v[60:63]
  v_exp_f32_e32 v126, v126
  v_mfma_f32_16x16x32_bf16 v[120:123], a[164:167], a[52:55], v[120:123]
  v_exp_f32_e32 v127, v127
  v_mfma_f32_16x16x32_bf16 v[120:123], a[168:171], a[56:59], v[120:123]
  buffer_load_dwordx4 v31, s[20:23], s47 offen offset:3072 lds
  v_cvt_pk_bf16_f32 v95, v126, v127
  v_mfma_f32_16x16x32_bf16 v[120:123], a[172:175], a[60:63], v[120:123]
  v_exp_f32_e32 v112, v112
  v_mfma_f32_16x16x32_bf16 v[124:127], a[176:179], a[48:51], v[60:63]
  v_exp_f32_e32 v113, v113
  v_mfma_f32_16x16x32_bf16 v[124:127], a[180:183], a[52:55], v[124:127]
  v_exp_f32_e32 v114, v114
  v_mfma_f32_16x16x32_bf16 v[124:127], a[184:187], a[56:59], v[124:127]
  v_exp_f32_e32 v115, v115
  v_mfma_f32_16x16x32_bf16 v[124:127], a[188:191], a[60:63], v[124:127]
  v_exp_f32_e32 v116, v116
  v_smfmac_f32_16x16x64_bf16 a[136:139], a[144:147], v[80:87], v29
  v_exp_f32_e32 v117, v117
  v_mfma_f32_16x16x32_bf16 v[192:195], a[192:195], v[84:87], v[192:195]
  v_exp_f32_e32 v118, v118
  v_mfma_f32_16x16x32_bf16 v[192:195], a[96:99], v[80:83], v[192:195]
  v_exp_f32_e32 v119, v119
  v_mfma_f32_16x16x32_bf16 v[196:199], a[100:103], v[80:83], v[196:199]
  v_exp_f32_e32 v120, v120
  v_mfma_f32_16x16x32_bf16 v[196:199], a[196:199], v[84:87], v[196:199]
  v_exp_f32_e32 v121, v121
  v_mfma_f32_16x16x32_bf16 v[200:203], a[200:203], v[84:87], v[200:203]
  v_exp_f32_e32 v122, v122
  v_mfma_f32_16x16x32_bf16 v[200:203], a[104:107], v[80:83], v[200:203]
  v_exp_f32_e32 v123, v123
  v_mfma_f32_16x16x32_bf16 v[204:207], a[108:111], v[80:83], v[204:207]
  v_exp_f32_e32 v124, v124
  v_mfma_f32_16x16x32_bf16 v[204:207], a[204:207], v[84:87], v[204:207]
  v_exp_f32_e32 v125, v125
  v_mfma_f32_16x16x32_bf16 v[208:211], a[208:211], v[84:87], v[208:211]
  v_exp_f32_e32 v126, v126
  v_mfma_f32_16x16x32_bf16 v[208:211], a[112:115], v[80:83], v[208:211]
  v_exp_f32_e32 v127, v127
  v_mfma_f32_16x16x32_bf16 v[212:215], a[116:119], v[80:83], v[212:215]
  v_exp_f32_e32 v104, v104
  v_mfma_f32_16x16x32_bf16 v[212:215], a[212:215], v[84:87], v[212:215]
  v_exp_f32_e32 v105, v105
  v_mfma_f32_16x16x32_bf16 v[216:219], a[216:219], v[84:87], v[216:219]
  v_cvt_pk_bf16_f32 v72, v104, v105
  v_mfma_f32_16x16x32_bf16 v[216:219], a[120:123], v[80:83], v[216:219]
  v_exp_f32_e32 v106, v106
  v_mfma_f32_16x16x32_bf16 v[220:223], a[124:127], v[80:83], v[220:223]
  v_cvt_pk_bf16_f32 v80, v112, v113
  v_cvt_pk_bf16_f32 v81, v114, v115
  v_mfma_f32_16x16x32_bf16 v[220:223], a[220:223], v[84:87], v[220:223]
  v_cvt_pk_bf16_f32 v82, v116, v117
  v_cvt_pk_bf16_f32 v83, v118, v119
  v_smfmac_f32_16x16x64_bf16 a[140:143], a[144:147], v[88:95], v29
  v_exp_f32_e32 v107, v107
  v_mfma_f32_16x16x32_bf16 v[224:227], a[192:195], v[92:95], v[224:227]
  v_cvt_pk_bf16_f32 v73, v106, v107
  v_mfma_f32_16x16x32_bf16 v[224:227], a[96:99], v[88:91], v[224:227]
  v_exp_f32_e32 v108, v108
  v_mfma_f32_16x16x32_bf16 v[228:231], a[100:103], v[88:91], v[228:231]
  v_exp_f32_e32 v109, v109
  v_mfma_f32_16x16x32_bf16 v[228:231], a[196:199], v[92:95], v[228:231]
  v_cvt_pk_bf16_f32 v74, v108, v109
  v_mfma_f32_16x16x32_bf16 v[232:235], a[200:203], v[92:95], v[232:235]
  v_exp_f32_e32 v110, v110
  v_mfma_f32_16x16x32_bf16 v[232:235], a[104:107], v[88:91], v[232:235]
  v_exp_f32_e32 v111, v111
  v_mfma_f32_16x16x32_bf16 v[236:239], a[108:111], v[88:91], v[236:239]
  v_cvt_pk_bf16_f32 v75, v110, v111
  v_mfma_f32_16x16x32_bf16 v[236:239], a[204:207], v[92:95], v[236:239]
  s_waitcnt vmcnt(8) lgkmcnt(0)
  s_barrier
  v_mfma_f32_16x16x32_bf16 v[240:243], a[208:211], v[92:95], v[240:243]
  ds_read_b64_tr_b16 a[96:97], v36 offset:0
  ds_read_b64_tr_b16 a[98:99], v36 offset:4096
  v_mfma_f32_16x16x32_bf16 v[240:243], a[112:115], v[88:91], v[240:243]
  ds_read_b64_tr_b16 a[100:101], v37 offset:0
  ds_read_b64_tr_b16 a[102:103], v37 offset:4096
  v_mfma_f32_16x16x32_bf16 v[244:247], a[116:119], v[88:91], v[244:247]
  ds_read_b64_tr_b16 a[104:105], v38 offset:0
  ds_read_b64_tr_b16 a[106:107], v38 offset:4096
  v_mfma_f32_16x16x32_bf16 v[244:247], a[212:215], v[92:95], v[244:247]
  ds_read_b64_tr_b16 a[108:109], v39 offset:0
  ds_read_b64_tr_b16 a[110:111], v39 offset:4096
  v_mfma_f32_16x16x32_bf16 v[248:251], a[216:219], v[92:95], v[248:251]
  ds_read_b64_tr_b16 a[112:113], v40 offset:0
  ds_read_b64_tr_b16 a[114:115], v40 offset:4096
  v_mfma_f32_16x16x32_bf16 v[248:251], a[120:123], v[88:91], v[248:251]
  ds_read_b64_tr_b16 a[116:117], v41 offset:0
  ds_read_b64_tr_b16 a[118:119], v41 offset:4096
  ds_read_b64_tr_b16 a[120:121], v42 offset:0
  v_mfma_f32_16x16x32_bf16 v[252:255], a[124:127], v[88:91], v[252:255]
  ds_read_b64_tr_b16 a[122:123], v42 offset:4096
  ds_read_b64_tr_b16 a[124:125], v43 offset:0
  v_cvt_pk_bf16_f32 v88, v120, v121
  v_mfma_f32_16x16x32_bf16 v[252:255], a[220:223], v[92:95], v[252:255]
  ds_read_b64_tr_b16 a[126:127], v43 offset:4096
  v_cvt_pk_bf16_f32 v89, v122, v123
  v_mfma_f32_16x16x32_bf16 v[112:115], a[64:67], a[32:35], v[56:59]
  ds_read_b128 a[160:163], v32 offset:0
  ds_read_b128 a[164:167], v33 offset:0
  ds_read_b128 a[168:171], v34 offset:0
  v_cvt_pk_bf16_f32 v90, v124, v125
  v_mfma_f32_16x16x32_bf16 v[112:115], a[68:71], a[36:39], v[112:115]
  ds_read_b128 a[172:175], v35 offset:0
  ds_read_b128 a[176:179], v32 offset:4096
  ds_read_b128 a[180:183], v33 offset:4096
  v_cvt_pk_bf16_f32 v91, v126, v127
  v_mfma_f32_16x16x32_bf16 v[112:115], a[72:75], a[40:43], v[112:115]
  ds_read_b128 a[184:187], v34 offset:4096
  ds_read_b128 a[188:191], v35 offset:4096
  ds_read_b64_tr_b16 a[192:193], v36 offset:8192
  ds_read_b64_tr_b16 a[194:195], v36 offset:12288
  v_mfma_f32_16x16x32_bf16 v[112:115], a[76:79], a[44:47], v[112:115]
  ds_read_b64_tr_b16 a[196:197], v37 offset:8192
  ds_read_b64_tr_b16 a[198:199], v37 offset:12288
  ds_read_b64_tr_b16 a[200:201], v38 offset:8192
  ds_read_b64_tr_b16 a[202:203], v38 offset:12288
  v_mfma_f32_16x16x32_bf16 v[116:119], a[80:83], a[32:35], v[56:59]
  ds_read_b64_tr_b16 a[204:205], v39 offset:8192
  ds_read_b64_tr_b16 a[206:207], v39 offset:12288
  ds_read_b64_tr_b16 a[208:209], v40 offset:8192
  ds_read_b64_tr_b16 a[210:211], v40 offset:12288
  v_mfma_f32_16x16x32_bf16 v[116:119], a[84:87], a[36:39], v[116:119]
  ds_read_b64_tr_b16 a[212:213], v41 offset:8192
  ds_read_b64_tr_b16 a[214:215], v41 offset:12288
  v_exp_f32_e32 v112, v112
  v_mfma_f32_16x16x32_bf16 v[116:119], a[88:91], a[40:43], v[116:119]
  ds_read_b64_tr_b16 a[216:217], v42 offset:8192
  ds_read_b64_tr_b16 a[218:219], v42 offset:12288
  v_exp_f32_e32 v113, v113
  v_mfma_f32_16x16x32_bf16 v[116:119], a[92:95], a[44:47], v[116:119]
  ds_read_b64_tr_b16 a[220:221], v43 offset:8192
  ds_read_b64_tr_b16 a[222:223], v43 offset:12288
  v_cvt_pk_bf16_f32 v84, v112, v113
  v_mfma_f32_16x16x32_bf16 v[120:123], a[64:67], a[48:51], v[60:63]
  ds_read_b128 a[64:67], v32 offset:8192
  v_exp_f32_e32 v114, v114
  v_mfma_f32_16x16x32_bf16 v[120:123], a[68:71], a[52:55], v[120:123]
  ds_read_b128 a[68:71], v33 offset:8192
  v_exp_f32_e32 v115, v115
  v_mfma_f32_16x16x32_bf16 v[120:123], a[72:75], a[56:59], v[120:123]
  ds_read_b128 a[72:75], v34 offset:8192
  v_cvt_pk_bf16_f32 v85, v114, v115
  v_exp_f32_e32 v116, v116
  v_mfma_f32_16x16x32_bf16 v[120:123], a[76:79], a[60:63], v[120:123]
  ds_read_b128 a[76:79], v35 offset:8192
  v_exp_f32_e32 v117, v117
  v_mfma_f32_16x16x32_bf16 v[124:127], a[80:83], a[48:51], v[60:63]
  ds_read_b128 a[80:83], v32 offset:12288
  v_cvt_pk_bf16_f32 v86, v116, v117
  v_exp_f32_e32 v118, v118
  v_mfma_f32_16x16x32_bf16 v[124:127], a[84:87], a[52:55], v[124:127]
  ds_read_b128 a[84:87], v33 offset:12288
  v_exp_f32_e32 v120, v120
  v_mfma_f32_16x16x32_bf16 v[124:127], a[88:91], a[56:59], v[124:127]
  ds_read_b128 a[88:91], v34 offset:12288
  v_exp_f32_e32 v121, v121
  v_mfma_f32_16x16x32_bf16 v[124:127], a[92:95], a[60:63], v[124:127]
  ds_read_b128 a[92:95], v35 offset:12288
  v_cvt_pk_bf16_f32 v92, v120, v121
  v_exp_f32_e32 v122, v122
  v_smfmac_f32_16x16x64_bf16 a[132:135], a[144:147], v[72:79], v29
  v_exp_f32_e32 v123, v123
  v_exp_f32_e32 v119, v119
  v_cvt_pk_bf16_f32 v93, v122, v123
  v_cvt_pk_bf16_f32 v87, v118, v119
  s_waitcnt lgkmcnt(15)
  v_mfma_f32_16x16x32_bf16 v[160:163], a[96:99], v[72:75], v[160:163]
  v_exp_f32_e32 v124, v124
  v_exp_f32_e32 v125, v125
  v_exp_f32_e32 v126, v126
  v_mfma_f32_16x16x32_bf16 v[164:167], a[100:103], v[72:75], v[164:167]
  v_accvgpr_read_b32 v9, a132
  v_accvgpr_read_b32 v5, a133
  v_add_f32 v9, v9, v5
  v_rcp_f32 v14, v9
  v_cmp_nge_f32 vcc, s53, v9
  v_mfma_f32_16x16x32_bf16 v[168:171], a[104:107], v[72:75], v[168:171]
  s_or_b64 s[44:45], s[44:45], vcc
  v_mul_f32_e64 v52, -v3, v14
  v_cvt_pk_bf16_f32 v94, v124, v125
  v_exp_f32_e32 v127, v127
  v_fma_f32 v160, v160, v14, v52
  v_mfma_f32_16x16x32_bf16 v[172:175], a[108:111], v[72:75], v[172:175]
  v_cvt_pk_bf16_f32 v95, v126, v127
  v_fma_f32 v161, v161, v14, v52
  v_fma_f32 v162, v162, v14, v52
  v_fma_f32 v163, v163, v14, v52
  v_max3_f32 v54, |v160|, |v161|, |v162|
  v_cvt_pk_bf16_f32 v160, v160, v161
  v_mfma_f32_16x16x32_bf16 v[176:179], a[112:115], v[72:75], v[176:179]
  v_cvt_pk_bf16_f32 v161, v162, v163
  v_fma_f32 v164, v164, v14, v52
  v_fma_f32 v165, v165, v14, v52
  v_fma_f32 v166, v166, v14, v52
  v_fma_f32 v167, v167, v14, v52
  v_max3_f32 v54, v54, |v164|, |v165|
  v_mfma_f32_16x16x32_bf16 v[180:183], a[116:119], v[72:75], v[180:183]
  ds_write_b64 v28, v[160:161] offset:0
  v_max3_f32 v54, v54, |v166|, |v167|
  v_mul_f32 v54, 0x44800000, v54
  v_cmp_nge_f32_e64 vcc, v54, |v52|
  s_or_b64 s[44:45], s[44:45], vcc
  v_mfma_f32_16x16x32_bf16 v[184:187], a[120:123], v[72:75], v[184:187]
  v_cvt_pk_bf16_f32 v164, v164, v165
  v_cvt_pk_bf16_f32 v165, v166, v167
  v_fma_f32 v168, v168, v14, v52
  v_fma_f32 v169, v169, v14, v52
  v_fma_f32 v170, v170, v14, v52
  v_fma_f32 v171, v171, v14, v52
  v_mfma_f32_16x16x32_bf16 v[188:191], a[124:127], v[72:75], v[188:191]
  ds_write_b64 v28, v[164:165] offset:32
  v_cvt_pk_bf16_f32 v168, v168, v169
  v_cvt_pk_bf16_f32 v169, v170, v171
  v_fma_f32 v172, v172, v14, v52
  v_fma_f32 v173, v173, v14, v52
  v_mfma_f32_16x16x32_bf16 v[120:123], a[160:163], a[48:51], v[60:63]
  ds_write_b64 v28, v[168:169] offset:64
  v_fma_f32 v174, v174, v14, v52
  v_fma_f32 v175, v175, v14, v52
  v_cvt_pk_bf16_f32 v172, v172, v173
  v_cvt_pk_bf16_f32 v173, v174, v175
  v_mfma_f32_16x16x32_bf16 v[120:123], a[164:167], a[52:55], v[120:123]
  ds_write_b64 v28, v[172:173] offset:96
  ds_read_b128 v[164:167], v24 offset:0
  ds_read_b128 v[172:175], v24 offset:3200
  v_fma_f32 v176, v176, v14, v52
  v_fma_f32 v177, v177, v14, v52
  v_mfma_f32_16x16x32_bf16 v[120:123], a[168:171], a[56:59], v[120:123]
  v_fma_f32 v178, v178, v14, v52
  v_fma_f32 v179, v179, v14, v52
  v_cvt_pk_bf16_f32 v176, v176, v177
  v_cvt_pk_bf16_f32 v177, v178, v179
  v_mfma_f32_16x16x32_bf16 v[120:123], a[172:175], a[60:63], v[120:123]
  ds_write_b64 v28, v[176:177] offset:128
  v_fma_f32 v180, v180, v14, v52
  v_fma_f32 v181, v181, v14, v52
  v_fma_f32 v182, v182, v14, v52
  v_fma_f32 v183, v183, v14, v52
  v_mfma_f32_16x16x32_bf16 v[124:127], a[176:179], a[48:51], v[60:63]
  v_cvt_pk_bf16_f32 v180, v180, v181
  v_cvt_pk_bf16_f32 v181, v182, v183
  v_fma_f32 v184, v184, v14, v52
  v_fma_f32 v185, v185, v14, v52
  v_fma_f32 v186, v186, v14, v52
  v_fma_f32 v187, v187, v14, v52
  v_mfma_f32_16x16x32_bf16 v[124:127], a[180:183], a[52:55], v[124:127]
  ds_write_b64 v28, v[180:181] offset:160
  v_cvt_pk_bf16_f32 v184, v184, v185
  v_cvt_pk_bf16_f32 v185, v186, v187
  v_mfma_f32_16x16x32_bf16 v[124:127], a[184:187], a[56:59], v[124:127]
  ds_write_b64 v28, v[184:185] offset:192
  v_fma_f32 v188, v188, v14, v52
  v_mfma_f32_16x16x32_bf16 v[124:127], a[188:191], a[60:63], v[124:127]
  v_fma_f32 v189, v189, v14, v52
  v_fma_f32 v190, v190, v14, v52
  v_fma_f32 v191, v191, v14, v52
  s_waitcnt lgkmcnt(15)
  v_mfma_f32_16x16x32_bf16 v[96:99], a[64:67], a[48:51], v[60:63]
  v_cvt_pk_bf16_f32 v188, v188, v189
  v_cvt_pk_bf16_f32 v189, v190, v191
  v_mfma_f32_16x16x32_bf16 v[96:99], a[68:71], a[52:55], v[96:99]
  ds_write_b64 v28, v[188:189] offset:224
  ds_read_b128 v[180:183], v24 offset:128
  s_waitcnt lgkmcnt(15)
  v_mfma_f32_16x16x32_bf16 v[96:99], a[72:75], a[56:59], v[96:99]
  ds_read_b128 v[188:191], v24 offset:3328
  v_exp_f32_e32 v120, v120
  v_mfma_f32_16x16x32_bf16 v[96:99], a[76:79], a[60:63], v[96:99]
  s_waitcnt lgkmcnt(7)
  buffer_store_dwordx4 v[164:167], v27, s[24:27], s41 offen offset:0 sc0 sc1
  v_exp_f32_e32 v121, v121
  v_mfma_f32_16x16x32_bf16 v[100:103], a[80:83], a[48:51], v[60:63]
  v_exp_f32_e32 v122, v122
  v_mfma_f32_16x16x32_bf16 v[100:103], a[84:87], a[52:55], v[100:103]
  s_waitcnt lgkmcnt(6)
  buffer_store_dwordx4 v[172:175], v27, s[24:27], s41 offen offset:2048 sc0 sc1
  v_exp_f32_e32 v123, v123
  v_mfma_f32_16x16x32_bf16 v[100:103], a[88:91], a[56:59], v[100:103]
  v_exp_f32_e32 v124, v124
  v_mfma_f32_16x16x32_bf16 v[100:103], a[92:95], a[60:63], v[100:103]
  v_exp_f32_e32 v125, v125
  v_smfmac_f32_16x16x64_bf16 a[136:139], a[144:147], v[80:87], v29
  v_exp_f32_e32 v126, v126
  v_mfma_f32_16x16x32_bf16 v[192:195], a[192:195], v[84:87], v[192:195]
  s_waitcnt lgkmcnt(1)
  buffer_store_dwordx4 v[180:183], v27, s[24:27], s41 offen offset:128 sc0 sc1
  v_exp_f32_e32 v127, v127
  v_mfma_f32_16x16x32_bf16 v[192:195], a[96:99], v[80:83], v[192:195]
  s_waitcnt lgkmcnt(0)
  buffer_store_dwordx4 v[188:191], v27, s[24:27], s41 offen offset:2176 sc0 sc1
  s_waitcnt vmcnt(4) lgkmcnt(0)
  s_barrier
  v_accvgpr_read_b32 v10, a136
  v_mfma_f32_16x16x32_bf16 v[196:199], a[100:103], v[80:83], v[196:199]
  ds_read_b64_tr_b16 a[64:65], v36 offset:24576
  ds_read_b64_tr_b16 a[66:67], v36 offset:28672
  ds_read_b64_tr_b16 a[160:161], v36 offset:16384
  v_accvgpr_read_b32 v6, a137
  v_mfma_f32_16x16x32_bf16 v[196:199], a[196:199], v[84:87], v[196:199]
  ds_read_b64_tr_b16 a[162:163], v36 offset:20480
  ds_read_b64_tr_b16 a[164:165], v37 offset:16384
  ds_read_b64_tr_b16 a[166:167], v37 offset:20480
  v_add_f32 v10, v10, v6
  v_mfma_f32_16x16x32_bf16 v[200:203], a[200:203], v[84:87], v[200:203]
  ds_read_b64_tr_b16 a[68:69], v37 offset:24576
  ds_read_b64_tr_b16 a[70:71], v37 offset:28672
  v_rcp_f32 v16, v10
  v_mfma_f32_16x16x32_bf16 v[200:203], a[104:107], v[80:83], v[200:203]
  ds_read_b64_tr_b16 a[72:73], v38 offset:24576
  ds_read_b64_tr_b16 a[74:75], v38 offset:28672
  ds_read_b64_tr_b16 a[168:169], v38 offset:16384
  v_cmp_nge_f32 vcc, s53, v10
  v_mfma_f32_16x16x32_bf16 v[204:207], a[108:111], v[80:83], v[204:207]
  ds_read_b64_tr_b16 a[170:171], v38 offset:20480
  ds_read_b64_tr_b16 a[172:173], v39 offset:16384
  ds_read_b64_tr_b16 a[174:175], v39 offset:20480
  s_or_b64 s[44:45], s[44:45], vcc
  v_mfma_f32_16x16x32_bf16 v[204:207], a[204:207], v[84:87], v[204:207]
  ds_read_b64_tr_b16 a[76:77], v39 offset:24576
  ds_read_b64_tr_b16 a[78:79], v39 offset:28672
  ds_read_b64_tr_b16 a[80:81], v40 offset:24576
  ds_read_b64_tr_b16 a[82:83], v40 offset:28672
  ds_read_b64_tr_b16 a[176:177], v40 offset:16384
  v_mul_f32_e64 v56, -v3, v16
  v_mfma_f32_16x16x32_bf16 v[208:211], a[208:211], v[84:87], v[208:211]
  ds_read_b64_tr_b16 a[178:179], v40 offset:20480
  ds_read_b64_tr_b16 a[180:181], v41 offset:16384
  ds_read_b64_tr_b16 a[182:183], v41 offset:20480
  ds_read_b64_tr_b16 a[84:85], v41 offset:24576
  ds_read_b64_tr_b16 a[86:87], v41 offset:28672
  v_fma_f32 v192, v192, v16, v56
  v_mfma_f32_16x16x32_bf16 v[208:211], a[112:115], v[80:83], v[208:211]
  ds_read_b64_tr_b16 a[88:89], v42 offset:24576
  ds_read_b64_tr_b16 a[90:91], v42 offset:28672
  ds_read_b64_tr_b16 a[184:185], v42 offset:16384
  ds_read_b64_tr_b16 a[186:187], v42 offset:20480
  ds_read_b64_tr_b16 a[188:189], v43 offset:16384
  v_fma_f32 v193, v193, v16, v56
  v_mfma_f32_16x16x32_bf16 v[212:215], a[116:119], v[80:83], v[212:215]
  ds_read_b64_tr_b16 a[190:191], v43 offset:20480
  ds_read_b64_tr_b16 a[92:93], v43 offset:24576
  ds_read_b64_tr_b16 a[94:95], v43 offset:28672
  v_fma_f32 v194, v194, v16, v56
  v_fma_f32 v195, v195, v16, v56
  v_max3_f32 v58, |v192|, |v193|, |v194|
  v_mfma_f32_16x16x32_bf16 v[212:215], a[212:215], v[84:87], v[212:215]
  v_cvt_pk_bf16_f32 v192, v192, v193
  v_cvt_pk_bf16_f32 v193, v194, v195
  v_fma_f32 v196, v196, v16, v56
  v_fma_f32 v197, v197, v16, v56
  v_fma_f32 v198, v198, v16, v56
  v_fma_f32 v199, v199, v16, v56
  v_mfma_f32_16x16x32_bf16 v[216:219], a[216:219], v[84:87], v[216:219]
  ds_write_b64 v28, v[192:193] offset:0
  v_max3_f32 v58, v58, |v196|, |v197|
  v_max3_f32 v58, v58, |v198|, |v199|
  v_mul_f32 v58, 0x44800000, v58
  v_cmp_nge_f32_e64 vcc, v58, |v56|
  v_mfma_f32_16x16x32_bf16 v[216:219], a[120:123], v[80:83], v[216:219]
  s_or_b64 s[44:45], s[44:45], vcc
  v_cvt_pk_bf16_f32 v196, v196, v197
  v_cvt_pk_bf16_f32 v197, v198, v199
  v_fma_f32 v200, v200, v16, v56
  v_fma_f32 v201, v201, v16, v56
  v_fma_f32 v202, v202, v16, v56
  v_mfma_f32_16x16x32_bf16 v[220:223], a[124:127], v[80:83], v[220:223]
  ds_write_b64 v28, v[196:197] offset:32
  v_fma_f32 v203, v203, v16, v56
  v_cvt_pk_bf16_f32 v200, v200, v201
  v_cvt_pk_bf16_f32 v201, v202, v203
  v_fma_f32 v204, v204, v16, v56
  v_mfma_f32_16x16x32_bf16 v[220:223], a[220:223], v[84:87], v[220:223]
  ds_write_b64 v28, v[200:201] offset:64
  v_fma_f32 v205, v205, v16, v56
  v_fma_f32 v206, v206, v16, v56
  v_fma_f32 v207, v207, v16, v56
  v_cvt_pk_bf16_f32 v204, v204, v205
  v_smfmac_f32_16x16x64_bf16 a[140:143], a[144:147], v[88:95], v29
  v_cvt_pk_bf16_f32 v205, v206, v207
  v_fma_f32 v208, v208, v16, v56
  v_fma_f32 v209, v209, v16, v56
  v_fma_f32 v210, v210, v16, v56
  v_fma_f32 v211, v211, v16, v56
  v_cvt_pk_bf16_f32 v208, v208, v209
  v_mfma_f32_16x16x32_bf16 v[224:227], a[192:195], v[92:95], v[224:227]
  ds_write_b64 v28, v[204:205] offset:96
  ds_read_b128 v[196:199], v24 offset:0
  ds_read_b128 v[204:207], v24 offset:3200
  v_mfma_f32_16x16x32_bf16 v[224:227], a[96:99], v[88:91], v[224:227]
  v_cvt_pk_bf16_f32 v209, v210, v211
  v_fma_f32 v212, v212, v16, v56
  v_fma_f32 v213, v213, v16, v56
  v_fma_f32 v214, v214, v16, v56
  v_mfma_f32_16x16x32_bf16 v[228:231], a[100:103], v[88:91], v[228:231]
  ds_write_b64 v28, v[208:209] offset:128
  v_fma_f32 v215, v215, v16, v56
  v_cvt_pk_bf16_f32 v212, v212, v213
  v_cvt_pk_bf16_f32 v213, v214, v215
  v_fma_f32 v216, v216, v16, v56
  v_mfma_f32_16x16x32_bf16 v[228:231], a[196:199], v[92:95], v[228:231]
  ds_write_b64 v28, v[212:213] offset:160
  v_fma_f32 v217, v217, v16, v56
  v_fma_f32 v218, v218, v16, v56
  v_fma_f32 v219, v219, v16, v56
  v_cvt_pk_bf16_f32 v216, v216, v217
  v_mfma_f32_16x16x32_bf16 v[232:235], a[200:203], v[92:95], v[232:235]
  v_cvt_pk_bf16_f32 v217, v218, v219
  v_fma_f32 v220, v220, v16, v56
  v_fma_f32 v221, v221, v16, v56
  v_fma_f32 v222, v222, v16, v56
  v_mfma_f32_16x16x32_bf16 v[232:235], a[104:107], v[88:91], v[232:235]
  ds_write_b64 v28, v[216:217] offset:192
  v_fma_f32 v223, v223, v16, v56
  v_mfma_f32_16x16x32_bf16 v[236:239], a[108:111], v[88:91], v[236:239]
  v_cvt_pk_bf16_f32 v220, v220, v221
  v_cvt_pk_bf16_f32 v221, v222, v223
  v_mfma_f32_16x16x32_bf16 v[236:239], a[204:207], v[92:95], v[236:239]
  ds_write_b64 v28, v[220:221] offset:224
  ds_read_b128 v[212:215], v24 offset:128
  v_mfma_f32_16x16x32_bf16 v[240:243], a[208:211], v[92:95], v[240:243]
  ds_read_b128 v[220:223], v24 offset:3328
  v_exp_f32_e32 v96, v96
  v_mfma_f32_16x16x32_bf16 v[240:243], a[112:115], v[88:91], v[240:243]
  v_exp_f32_e32 v97, v97
  v_exp_f32_e32 v98, v98
  v_mfma_f32_16x16x32_bf16 v[244:247], a[116:119], v[88:91], v[244:247]
  s_waitcnt lgkmcnt(7)
  buffer_store_dwordx4 v[196:199], v27, s[24:27], s42 offen offset:0 sc0 sc1
  v_exp_f32_e32 v99, v99
  v_mfma_f32_16x16x32_bf16 v[244:247], a[212:215], v[92:95], v[244:247]
  v_exp_f32_e32 v100, v100
  v_mfma_f32_16x16x32_bf16 v[248:251], a[216:219], v[92:95], v[248:251]
  s_waitcnt lgkmcnt(6)
  buffer_store_dwordx4 v[204:207], v27, s[24:27], s42 offen offset:2048 sc0 sc1
  v_exp_f32_e32 v101, v101
  v_mfma_f32_16x16x32_bf16 v[248:251], a[120:123], v[88:91], v[248:251]
  v_exp_f32_e32 v102, v102
  v_exp_f32_e32 v103, v103
  v_mfma_f32_16x16x32_bf16 v[252:255], a[124:127], v[88:91], v[252:255]
  s_waitcnt lgkmcnt(1)
  buffer_store_dwordx4 v[212:215], v27, s[24:27], s42 offen offset:128 sc0 sc1
  v_cvt_pk_bf16_f32 v88, v120, v121
  v_cvt_pk_bf16_f32 v89, v122, v123
  v_mfma_f32_16x16x32_bf16 v[252:255], a[220:223], v[92:95], v[252:255]
  v_cvt_pk_bf16_f32 v90, v124, v125
  v_cvt_pk_bf16_f32 v91, v126, v127
  v_cvt_pk_bf16_f32 v92, v96, v97
  v_cvt_pk_bf16_f32 v93, v98, v99
  v_cvt_pk_bf16_f32 v94, v100, v101
  v_cvt_pk_bf16_f32 v95, v102, v103
  s_nop 1
  v_smfmac_f32_16x16x64_bf16 a[140:143], a[144:147], v[88:95], v29
  s_waitcnt lgkmcnt(0)
  buffer_store_dwordx4 v[220:223], v27, s[24:27], s42 offen offset:2176 sc0 sc1
  v_mfma_f32_16x16x32_bf16 v[224:227], a[64:67], v[92:95], v[224:227]
  v_mfma_f32_16x16x32_bf16 v[224:227], a[160:163], v[88:91], v[224:227]
  v_mfma_f32_16x16x32_bf16 v[228:231], a[164:167], v[88:91], v[228:231]
  v_mfma_f32_16x16x32_bf16 v[228:231], a[68:71], v[92:95], v[228:231]
  v_mfma_f32_16x16x32_bf16 v[232:235], a[72:75], v[92:95], v[232:235]
  v_mfma_f32_16x16x32_bf16 v[232:235], a[168:171], v[88:91], v[232:235]
  v_mfma_f32_16x16x32_bf16 v[236:239], a[172:175], v[88:91], v[236:239]
  v_accvgpr_read_b32 v11, a140
  v_accvgpr_read_b32 v7, a141
  v_add_f32 v11, v11, v7
  v_mfma_f32_16x16x32_bf16 v[236:239], a[76:79], v[92:95], v[236:239]
  v_rcp_f32 v18, v11
  v_cmp_nge_f32 vcc, s53, v11
  s_or_b64 s[44:45], s[44:45], vcc
  v_mov_b32 v19, v18
  v_mul_f32_e64 v60, -v3, v18
  v_mfma_f32_16x16x32_bf16 v[240:243], a[80:83], v[92:95], v[240:243]
  v_mov_b32 v61, v60
  v_fma_f32 v224, v224, v18, v60
  v_fma_f32 v225, v225, v18, v60
  v_fma_f32 v226, v226, v18, v60
  v_fma_f32 v227, v227, v18, v60
  v_max3_f32 v62, |v224|, |v225|, |v226|
  v_mfma_f32_16x16x32_bf16 v[240:243], a[176:179], v[88:91], v[240:243]
  v_cvt_pk_bf16_f32 v224, v224, v225
  v_cvt_pk_bf16_f32 v225, v226, v227
  v_fma_f32 v228, v228, v18, v60
  v_fma_f32 v229, v229, v18, v60
  v_mfma_f32_16x16x32_bf16 v[244:247], a[180:183], v[88:91], v[244:247]
  ds_write_b64 v28, v[224:225] offset:0
  v_fma_f32 v230, v230, v18, v60
  v_fma_f32 v231, v231, v18, v60
  v_mfma_f32_16x16x32_bf16 v[244:247], a[84:87], v[92:95], v[244:247]
  v_max3_f32 v62, v62, |v228|, |v229|
  v_max3_f32 v62, v62, |v230|, |v231|
  v_mul_f32 v62, 0x44800000, v62
  v_cmp_nge_f32_e64 vcc, v62, |v60|
  s_or_b64 s[44:45], s[44:45], vcc
  v_cvt_pk_bf16_f32 v228, v228, v229
  v_mfma_f32_16x16x32_bf16 v[248:251], a[88:91], v[92:95], v[248:251]
  v_cvt_pk_bf16_f32 v229, v230, v231
  v_fma_f32 v232, v232, v18, v60
  v_fma_f32 v233, v233, v18, v60
  v_fma_f32 v234, v234, v18, v60
  v_fma_f32 v235, v235, v18, v60
  v_cvt_pk_bf16_f32 v232, v232, v233
  v_mfma_f32_16x16x32_bf16 v[248:251], a[184:187], v[88:91], v[248:251]
  ds_write_b64 v28, v[228:229] offset:32
  v_cvt_pk_bf16_f32 v233, v234, v235
  v_mfma_f32_16x16x32_bf16 v[252:255], a[188:191], v[88:91], v[252:255]
  ds_write_b64 v28, v[232:233] offset:64
  v_mfma_f32_16x16x32_bf16 v[252:255], a[92:95], v[92:95], v[252:255]
  v_pk_fma_f32 v[236:237], v[236:237], v[18:19], v[60:61]
  v_pk_fma_f32 v[238:239], v[238:239], v[18:19], v[60:61]
  v_cvt_pk_bf16_f32 v236, v236, v237
  v_cvt_pk_bf16_f32 v237, v238, v239
  v_pk_fma_f32 v[240:241], v[240:241], v[18:19], v[60:61]
  v_pk_fma_f32 v[242:243], v[242:243], v[18:19], v[60:61]
  ds_write_b64 v28, v[236:237] offset:96
  ds_read_b128 v[228:231], v24 offset:0
  ds_read_b128 v[236:239], v24 offset:3200
  v_cvt_pk_bf16_f32 v240, v240, v241
  v_cvt_pk_bf16_f32 v241, v242, v243
  ds_write_b64 v28, v[240:241] offset:128
  v_pk_fma_f32 v[244:245], v[244:245], v[18:19], v[60:61]
  v_pk_fma_f32 v[246:247], v[246:247], v[18:19], v[60:61]
  v_cvt_pk_bf16_f32 v244, v244, v245
  v_cvt_pk_bf16_f32 v245, v246, v247
  ds_write_b64 v28, v[244:245] offset:160
  v_pk_fma_f32 v[248:249], v[248:249], v[18:19], v[60:61]
  v_pk_fma_f32 v[250:251], v[250:251], v[18:19], v[60:61]
  v_cvt_pk_bf16_f32 v248, v248, v249
  v_cvt_pk_bf16_f32 v249, v250, v251
  ds_write_b64 v28, v[248:249] offset:192
  v_pk_fma_f32 v[252:253], v[252:253], v[18:19], v[60:61]
  v_pk_fma_f32 v[254:255], v[254:255], v[18:19], v[60:61]
  v_cvt_pk_bf16_f32 v252, v252, v253
  v_cvt_pk_bf16_f32 v253, v254, v255
  ds_write_b64 v28, v[252:253] offset:224
  ds_read_b128 v[244:247], v24 offset:128
  ds_read_b128 v[252:255], v24 offset:3328
  s_waitcnt lgkmcnt(7)
  buffer_store_dwordx4 v[228:231], v27, s[24:27], s43 offen offset:0 sc0 sc1
  s_waitcnt lgkmcnt(6)
  buffer_store_dwordx4 v[236:239], v27, s[24:27], s43 offen offset:2048 sc0 sc1
  s_waitcnt lgkmcnt(1)
  buffer_store_dwordx4 v[244:247], v27, s[24:27], s43 offen offset:128 sc0 sc1
  s_waitcnt lgkmcnt(0)
  buffer_store_dwordx4 v[252:255], v27, s[24:27], s43 offen offset:2176 sc0 sc1
  s_cmp_lg_u64 s[44:45], 0
  s_cbranch_scc1 L_slow
L_fin:
L_end:
  s_endpgm
L_wait0:
  ds_read_b32 v23, v21
  s_waitcnt lgkmcnt(0)
  v_cmp_gt_u32 vcc, v22, v23
  s_nop 4
  s_cbranch_vccnz L_wait0
  s_branch L_go0
L_wait1:
  ds_read_b32 v23, v21
  s_waitcnt lgkmcnt(0)
  v_cmp_gt_u32 vcc, v22, v23
  s_nop 4
  s_cbranch_vccnz L_wait1
  s_branch L_go1
L_wait2:
  ds_read_b32 v23, v21
  s_waitcnt lgkmcnt(0)
  v_cmp_gt_u32 vcc, v22, v23
  s_nop 4
  s_cbranch_vccnz L_wait2
  s_branch L_go2
L_wait3:
  ds_read_b32 v23, v21
  s_waitcnt lgkmcnt(0)
  v_cmp_gt_u32 vcc, v22, v23
  s_nop 4
  s_cbranch_vccnz L_wait3
  s_branch L_go3
L_slow:
  s_waitcnt vmcnt(0) lgkmcnt(0)
  v_lshlrev_b32 v14, 8, v1
  v_lshl_add_u32 v14, v2, 4, v14
  s_lshl_b32 s46, s38, 12
  v_subrev_u32 v15, s46, v30
  v_subrev_u32 v16, s46, v31
  s_lshl_b32 s47, s38, 13
  s_add_u32 s47, s47, 0x20000
  s_sub_u32 s48, s47, 0x10000
  v_add_u32 v36, s48, v36
  v_add_u32 v37, s48, v37
  v_add_u32 v38, s48, v38
  v_add_u32 v39, s48, v39
  v_add_u32 v40, s48, v40
  v_add_u32 v41, s48, v41
  v_add_u32 v42, s48, v42
  v_add_u32 v43, s48, v43
  s_add_u32 s48, s47, 0x1000
  v_mov_b64 v[128:129], 0
  v_mov_b64 v[130:131], 0
  v_mov_b64 v[132:133], 0
  v_mov_b64 v[134:135], 0
  v_mov_b64 v[136:137], 0
  v_mov_b64 v[138:139], 0
  v_mov_b64 v[140:141], 0
  v_mov_b64 v[142:143], 0
  v_mov_b64 v[144:145], 0
  v_mov_b64 v[146:147], 0
  v_mov_b64 v[148:149], 0
  v_mov_b64 v[150:151], 0
  v_mov_b64 v[152:153], 0
  v_mov_b64 v[154:155], 0
  v_mov_b64 v[156:157], 0
  v_mov_b64 v[158:159], 0
  v_mov_b64 v[160:161], 0
  v_mov_b64 v[162:163], 0
  v_mov_b64 v[164:165], 0
  v_mov_b64 v[166:167], 0
  v_mov_b64 v[168:169], 0
  v_mov_b64 v[170:171], 0
  v_mov_b64 v[172:173], 0
  v_mov_b64 v[174:175], 0
  v_mov_b64 v[176:177], 0
  v_mov_b64 v[178:179], 0
  v_mov_b64 v[180:181], 0
  v_mov_b64 v[182:183], 0
  v_mov_b64 v[184:185], 0
  v_mov_b64 v[186:187], 0
  v_mov_b64 v[188:189], 0
  v_mov_b64 v[190:191], 0
  v_mov_b64 v[192:193], 0
  v_mov_b64 v[194:195], 0
  v_mov_b64 v[196:197], 0
  v_mov_b64 v[198:199], 0
  v_mov_b64 v[200:201], 0
  v_mov_b64 v[202:203], 0
  v_mov_b64 v[204:205], 0
  v_mov_b64 v[206:207], 0
  v_mov_b64 v[208:209], 0
  v_mov_b64 v[210:211], 0
  v_mov_b64 v[212:213], 0
  v_mov_b64 v[214:215], 0
  v_mov_b64 v[216:217], 0
  v_mov_b64 v[218:219], 0
  v_mov_b64 v[220:221], 0
  v_mov_b64 v[222:223], 0
  v_mov_b64 v[224:225], 0
  v_mov_b64 v[226:227], 0
  v_mov_b64 v[228:229], 0
  v_mov_b64 v[230:231], 0
  v_mov_b64 v[232:233], 0
  v_mov_b64 v[234:235], 0
  v_mov_b64 v[236:237], 0
  v_mov_b64 v[238:239], 0
  v_mov_b64 v[240:241], 0
  v_mov_b64 v[242:243], 0
  v_mov_b64 v[244:245], 0
  v_mov_b64 v[246:247], 0
  v_mov_b64 v[248:249], 0
  v_mov_b64 v[250:251], 0
  v_mov_b64 v[252:253], 0
  v_mov_b64 v[254:255], 0
  v_mov_b32 v48, 0xff7fffff
  v_mov_b32 v8, 0
  v_mov_b32 v49, 0xff7fffff
  v_mov_b32 v9, 0
  v_mov_b32 v50, 0xff7fffff
  v_mov_b32 v10, 0
  v_mov_b32 v51, 0xff7fffff
  v_mov_b32 v11, 0
  s_mov_b32 s50, 0
L_slow_loop:
  s_add_u32 s51, s50, 0x1000
  buffer_load_dwordx4 a[64:67], v14, s[16:19], s50 offen offset:0
  buffer_load_dwordx4 a[68:71], v14, s[16:19], s50 offen offset:64
  buffer_load_dwordx4 a[72:75], v14, s[16:19], s50 offen offset:128
  buffer_load_dwordx4 a[76:79], v14, s[16:19], s50 offen offset:192
  buffer_load_dwordx4 a[80:83], v14, s[16:19], s51 offen offset:0
  buffer_load_dwordx4 a[84:87], v14, s[16:19], s51 offen offset:64
  buffer_load_dwordx4 a[88:91], v14, s[16:19], s51 offen offset:128
  buffer_load_dwordx4 a[92:95], v14, s[16:19], s51 offen offset:192
  s_mov_b32 m0, s47
  s_nop 0
  buffer_load_dwordx4 v15, s[20:23], s50 offen offset:0 lds
  buffer_load_dwordx4 v16, s[20:23], s50 offen offset:1024 lds
  buffer_load_dwordx4 v15, s[20:23], s50 offen offset:2048 lds
  buffer_load_dwordx4 v16, s[20:23], s50 offen offset:3072 lds
  s_mov_b32 m0, s48
  s_nop 0
  buffer_load_dwordx4 v15, s[20:23], s51 offen offset:0 lds
  buffer_load_dwordx4 v16, s[20:23], s51 offen offset:1024 lds
  buffer_load_dwordx4 v15, s[20:23], s51 offen offset:2048 lds
  buffer_load_dwordx4 v16, s[20:23], s51 offen offset:3072 lds
  s_waitcnt vmcnt(0)
  ds_read_b64_tr_b16 a[96:97], v36 offset:0
  ds_read_b64_tr_b16 a[98:99], v36 offset:4096
  ds_read_b64_tr_b16 a[100:101], v37 offset:0
  ds_read_b64_tr_b16 a[102:103], v37 offset:4096
  ds_read_b64_tr_b16 a[104:105], v38 offset:0
  ds_read_b64_tr_b16 a[106:107], v38 offset:4096
  ds_read_b64_tr_b16 a[108:109], v39 offset:0
  ds_read_b64_tr_b16 a[110:111], v39 offset:4096
  ds_read_b64_tr_b16 a[112:113], v40 offset:0
  ds_read_b64_tr_b16 a[114:115], v40 offset:4096
  ds_read_b64_tr_b16 a[116:117], v41 offset:0
  ds_read_b64_tr_b16 a[118:119], v41 offset:4096
  ds_read_b64_tr_b16 a[120:121], v42 offset:0
  ds_read_b64_tr_b16 a[122:123], v42 offset:4096
  ds_read_b64_tr_b16 a[124:125], v43 offset:0
  ds_read_b64_tr_b16 a[126:127], v43 offset:4096
  v_mfma_f32_16x16x32_bf16 v[96:99], a[64:67], a[0:3], 0
  v_mfma_f32_16x16x32_bf16 v[96:99], a[68:71], a[4:7], v[96:99]
  v_mfma_f32_16x16x32_bf16 v[96:99], a[72:75], a[8:11], v[96:99]
  v_mfma_f32_16x16x32_bf16 v[96:99], a[76:79], a[12:15], v[96:99]
  v_mfma_f32_16x16x32_bf16 v[100:103], a[80:83], a[0:3], 0
  v_mfma_f32_16x16x32_bf16 v[100:103], a[84:87], a[4:7], v[100:103]
  v_mfma_f32_16x16x32_bf16 v[100:103], a[88:91], a[8:11], v[100:103]
  v_mfma_f32_16x16x32_bf16 v[100:103], a[92:95], a[12:15], v[100:103]
  v_mfma_f32_16x16x32_bf16 v[104:107], a[64:67], a[16:19], 0
  v_mfma_f32_16x16x32_bf16 v[104:107], a[68:71], a[20:23], v[104:107]
  v_mfma_f32_16x16x32_bf16 v[104:107], a[72:75], a[24:27], v[104:107]
  v_mfma_f32_16x16x32_bf16 v[104:107], a[76:79], a[28:31], v[104:107]
  v_mfma_f32_16x16x32_bf16 v[108:111], a[80:83], a[16:19], 0
  v_mfma_f32_16x16x32_bf16 v[108:111], a[84:87], a[20:23], v[108:111]
  v_mfma_f32_16x16x32_bf16 v[108:111], a[88:91], a[24:27], v[108:111]
  v_mfma_f32_16x16x32_bf16 v[108:111], a[92:95], a[28:31], v[108:111]
  v_mfma_f32_16x16x32_bf16 v[112:115], a[64:67], a[32:35], 0
  v_mfma_f32_16x16x32_bf16 v[112:115], a[68:71], a[36:39], v[112:115]
  v_mfma_f32_16x16x32_bf16 v[112:115], a[72:75], a[40:43], v[112:115]
  v_mfma_f32_16x16x32_bf16 v[112:115], a[76:79], a[44:47], v[112:115]
  v_mfma_f32_16x16x32_bf16 v[116:119], a[80:83], a[32:35], 0
  v_mfma_f32_16x16x32_bf16 v[116:119], a[84:87], a[36:39], v[116:119]
  v_mfma_f32_16x16x32_bf16 v[116:119], a[88:91], a[40:43], v[116:119]
  v_mfma_f32_16x16x32_bf16 v[116:119], a[92:95], a[44:47], v[116:119]
  v_mfma_f32_16x16x32_bf16 v[120:123], a[64:67], a[48:51], 0
  v_mfma_f32_16x16x32_bf16 v[120:123], a[68:71], a[52:55], v[120:123]
  v_mfma_f32_16x16x32_bf16 v[120:123], a[72:75], a[56:59], v[120:123]
  v_mfma_f32_16x16x32_bf16 v[120:123], a[76:79], a[60:63], v[120:123]
  v_mfma_f32_16x16x32_bf16 v[124:127], a[80:83], a[48:51], 0
  v_mfma_f32_16x16x32_bf16 v[124:127], a[84:87], a[52:55], v[124:127]
  v_mfma_f32_16x16x32_bf16 v[124:127], a[88:91], a[56:59], v[124:127]
  v_mfma_f32_16x16x32_bf16 v[124:127], a[92:95], a[60:63], v[124:127]
  s_nop 7
  v_max3_f32 v4, v96, v97, v98
  v_max3_f32 v5, v99, v100, v101
  v_max3_f32 v4, v4, v102, v103
  v_max3_f32 v4, v4, v5, v48
  v_mov_b32 v5, v4
  s_nop 1
  v_permlane32_swap_b32 v4, v5
  v_max_f32 v4, v4, v5
  v_mov_b32 v5, v4
  s_nop 1
  v_permlane16_swap_b32 v4, v5
  v_max_f32 v4, v4, v5
  v_sub_f32 v6, v48, v4
  v_exp_f32 v6, v6
  v_mov_b32 v48, v4
  v_sub_f32 v96, v96, v4
  v_sub_f32 v97, v97, v4
  v_sub_f32 v98, v98, v4
  v_sub_f32 v99, v99, v4
  v_sub_f32 v100, v100, v4
  v_sub_f32 v101, v101, v4
  v_sub_f32 v102, v102, v4
  v_sub_f32 v103, v103, v4
  v_exp_f32 v96, v96
  v_exp_f32 v97, v97
  v_exp_f32 v98, v98
  v_exp_f32 v99, v99
  v_exp_f32 v100, v100
  v_exp_f32 v101, v101
  v_exp_f32 v102, v102
  v_exp_f32 v103, v103
  v_mul_f32 v8, v8, v6
  v_add_f32 v8, v8, v96
  v_add_f32 v8, v8, v97
  v_add_f32 v8, v8, v98
  v_add_f32 v8, v8, v99
  v_add_f32 v8, v8, v100
  v_add_f32 v8, v8, v101
  v_add_f32 v8, v8, v102
  v_add_f32 v8, v8, v103
  v_cvt_pk_bf16_f32 v64, v96, v97
  v_cvt_pk_bf16_f32 v65, v98, v99
  v_cvt_pk_bf16_f32 v66, v100, v101
  v_cvt_pk_bf16_f32 v67, v102, v103
  v_mul_f32 v128, v128, v6
  v_mul_f32 v129, v129, v6
  v_mul_f32 v130, v130, v6
  v_mul_f32 v131, v131, v6
  v_mul_f32 v132, v132, v6
  v_mul_f32 v133, v133, v6
  v_mul_f32 v134, v134, v6
  v_mul_f32 v135, v135, v6
  v_mul_f32 v136, v136, v6
  v_mul_f32 v137, v137, v6
  v_mul_f32 v138, v138, v6
  v_mul_f32 v139, v139, v6
  v_mul_f32 v140, v140, v6
  v_mul_f32 v141, v141, v6
  v_mul_f32 v142, v142, v6
  v_mul_f32 v143, v143, v6
  v_mul_f32 v144, v144, v6
  v_mul_f32 v145, v145, v6
  v_mul_f32 v146, v146, v6
  v_mul_f32 v147, v147, v6
  v_mul_f32 v148, v148, v6
  v_mul_f32 v149, v149, v6
  v_mul_f32 v150, v150, v6
  v_mul_f32 v151, v151, v6
  v_mul_f32 v152, v152, v6
  v_mul_f32 v153, v153, v6
  v_mul_f32 v154, v154, v6
  v_mul_f32 v155, v155, v6
  v_mul_f32 v156, v156, v6
  v_mul_f32 v157, v157, v6
  v_mul_f32 v158, v158, v6
  v_mul_f32 v159, v159, v6
  v_max3_f32 v4, v104, v105, v106
  v_max3_f32 v5, v107, v108, v109
  v_max3_f32 v4, v4, v110, v111
  v_max3_f32 v4, v4, v5, v49
  v_mov_b32 v5, v4
  s_nop 1
  v_permlane32_swap_b32 v4, v5
  v_max_f32 v4, v4, v5
  v_mov_b32 v5, v4
  s_nop 1
  v_permlane16_swap_b32 v4, v5
  v_max_f32 v4, v4, v5
  v_sub_f32 v6, v49, v4
  v_exp_f32 v6, v6
  v_mov_b32 v49, v4
  v_sub_f32 v104, v104, v4
  v_sub_f32 v105, v105, v4
  v_sub_f32 v106, v106, v4
  v_sub_f32 v107, v107, v4
  v_sub_f32 v108, v108, v4
  v_sub_f32 v109, v109, v4
  v_sub_f32 v110, v110, v4
  v_sub_f32 v111, v111, v4
  v_exp_f32 v104, v104
  v_exp_f32 v105, v105
  v_exp_f32 v106, v106
  v_exp_f32 v107, v107
  v_exp_f32 v108, v108
  v_exp_f32 v109, v109
  v_exp_f32 v110, v110
  v_exp_f32 v111, v111
  v_mul_f32 v9, v9, v6
  v_add_f32 v9, v9, v104
  v_add_f32 v9, v9, v105
  v_add_f32 v9, v9, v106
  v_add_f32 v9, v9, v107
  v_add_f32 v9, v9, v108
  v_add_f32 v9, v9, v109
  v_add_f32 v9, v9, v110
  v_add_f32 v9, v9, v111
  v_cvt_pk_bf16_f32 v72, v104, v105
  v_cvt_pk_bf16_f32 v73, v106, v107
  v_cvt_pk_bf16_f32 v74, v108, v109
  v_cvt_pk_bf16_f32 v75, v110, v111
  v_mul_f32 v160, v160, v6
  v_mul_f32 v161, v161, v6
  v_mul_f32 v162, v162, v6
  v_mul_f32 v163, v163, v6
  v_mul_f32 v164, v164, v6
  v_mul_f32 v165, v165, v6
  v_mul_f32 v166, v166, v6
  v_mul_f32 v167, v167, v6
  v_mul_f32 v168, v168, v6
  v_mul_f32 v169, v169, v6
  v_mul_f32 v170, v170, v6
  v_mul_f32 v171, v171, v6
  v_mul_f32 v172, v172, v6
  v_mul_f32 v173, v173, v6
  v_mul_f32 v174, v174, v6
  v_mul_f32 v175, v175, v6
  v_mul_f32 v176, v176, v6
  v_mul_f32 v177, v177, v6
  v_mul_f32 v178, v178, v6
  v_mul_f32 v179, v179, v6
  v_mul_f32 v180, v180, v6
  v_mul_f32 v181, v181, v6
  v_mul_f32 v182, v182, v6
  v_mul_f32 v183, v183, v6
  v_mul_f32 v184, v184, v6
  v_mul_f32 v185, v185, v6
  v_mul_f32 v186, v186, v6
  v_mul_f32 v187, v187, v6
  v_mul_f32 v188, v188, v6
  v_mul_f32 v189, v189, v6
  v_mul_f32 v190, v190, v6
  v_mul_f32 v191, v191, v6
  v_max3_f32 v4, v112, v113, v114
  v_max3_f32 v5, v115, v116, v117
  v_max3_f32 v4, v4, v118, v119
  v_max3_f32 v4, v4, v5, v50
  v_mov_b32 v5, v4
  s_nop 1
  v_permlane32_swap_b32 v4, v5
  v_max_f32 v4, v4, v5
  v_mov_b32 v5, v4
  s_nop 1
  v_permlane16_swap_b32 v4, v5
  v_max_f32 v4, v4, v5
  v_sub_f32 v6, v50, v4
  v_exp_f32 v6, v6
  v_mov_b32 v50, v4
  v_sub_f32 v112, v112, v4
  v_sub_f32 v113, v113, v4
  v_sub_f32 v114, v114, v4
  v_sub_f32 v115, v115, v4
  v_sub_f32 v116, v116, v4
  v_sub_f32 v117, v117, v4
  v_sub_f32 v118, v118, v4
  v_sub_f32 v119, v119, v4
  v_exp_f32 v112, v112
  v_exp_f32 v113, v113
  v_exp_f32 v114, v114
  v_exp_f32 v115, v115
  v_exp_f32 v116, v116
  v_exp_f32 v117, v117
  v_exp_f32 v118, v118
  v_exp_f32 v119, v119
  v_mul_f32 v10, v10, v6
  v_add_f32 v10, v10, v112
  v_add_f32 v10, v10, v113
  v_add_f32 v10, v10, v114
  v_add_f32 v10, v10, v115
  v_add_f32 v10, v10, v116
  v_add_f32 v10, v10, v117
  v_add_f32 v10, v10, v118
  v_add_f32 v10, v10, v119
  v_cvt_pk_bf16_f32 v80, v112, v113
  v_cvt_pk_bf16_f32 v81, v114, v115
  v_cvt_pk_bf16_f32 v82, v116, v117
  v_cvt_pk_bf16_f32 v83, v118, v119
  v_mul_f32 v192, v192, v6
  v_mul_f32 v193, v193, v6
  v_mul_f32 v194, v194, v6
  v_mul_f32 v195, v195, v6
  v_mul_f32 v196, v196, v6
  v_mul_f32 v197, v197, v6
  v_mul_f32 v198, v198, v6
  v_mul_f32 v199, v199, v6
  v_mul_f32 v200, v200, v6
  v_mul_f32 v201, v201, v6
  v_mul_f32 v202, v202, v6
  v_mul_f32 v203, v203, v6
  v_mul_f32 v204, v204, v6
  v_mul_f32 v205, v205, v6
  v_mul_f32 v206, v206, v6
  v_mul_f32 v207, v207, v6
  v_mul_f32 v208, v208, v6
  v_mul_f32 v209, v209, v6
  v_mul_f32 v210, v210, v6
  v_mul_f32 v211, v211, v6
  v_mul_f32 v212, v212, v6
  v_mul_f32 v213, v213, v6
  v_mul_f32 v214, v214, v6
  v_mul_f32 v215, v215, v6
  v_mul_f32 v216, v216, v6
  v_mul_f32 v217, v217, v6
  v_mul_f32 v218, v218, v6
  v_mul_f32 v219, v219, v6
  v_mul_f32 v220, v220, v6
  v_mul_f32 v221, v221, v6
  v_mul_f32 v222, v222, v6
  v_mul_f32 v223, v223, v6
  v_max3_f32 v4, v120, v121, v122
  v_max3_f32 v5, v123, v124, v125
  v_max3_f32 v4, v4, v126, v127
  v_max3_f32 v4, v4, v5, v51
  v_mov_b32 v5, v4
  s_nop 1
  v_permlane32_swap_b32 v4, v5
  v_max_f32 v4, v4, v5
  v_mov_b32 v5, v4
  s_nop 1
  v_permlane16_swap_b32 v4, v5
  v_max_f32 v4, v4, v5
  v_sub_f32 v6, v51, v4
  v_exp_f32 v6, v6
  v_mov_b32 v51, v4
  v_sub_f32 v120, v120, v4
  v_sub_f32 v121, v121, v4
  v_sub_f32 v122, v122, v4
  v_sub_f32 v123, v123, v4
  v_sub_f32 v124, v124, v4
  v_sub_f32 v125, v125, v4
  v_sub_f32 v126, v126, v4
  v_sub_f32 v127, v127, v4
  v_exp_f32 v120, v120
  v_exp_f32 v121, v121
  v_exp_f32 v122, v122
  v_exp_f32 v123, v123
  v_exp_f32 v124, v124
  v_exp_f32 v125, v125
  v_exp_f32 v126, v126
  v_exp_f32 v127, v127
  v_mul_f32 v11, v11, v6
  v_add_f32 v11, v11, v120
  v_add_f32 v11, v11, v121
  v_add_f32 v11, v11, v122
  v_add_f32 v11, v11, v123
  v_add_f32 v11, v11, v124
  v_add_f32 v11, v11, v125
  v_add_f32 v11, v11, v126
  v_add_f32 v11, v11, v127
  v_cvt_pk_bf16_f32 v88, v120, v121
  v_cvt_pk_bf16_f32 v89, v122, v123
  v_cvt_pk_bf16_f32 v90, v124, v125
  v_cvt_pk_bf16_f32 v91, v126, v127
  v_mul_f32 v224, v224, v6
  v_mul_f32 v225, v225, v6
  v_mul_f32 v226, v226, v6
  v_mul_f32 v227, v227, v6
  v_mul_f32 v228, v228, v6
  v_mul_f32 v229, v229, v6
  v_mul_f32 v230, v230, v6
  v_mul_f32 v231, v231, v6
  v_mul_f32 v232, v232, v6
  v_mul_f32 v233, v233, v6
  v_mul_f32 v234, v234, v6
  v_mul_f32 v235, v235, v6
  v_mul_f32 v236, v236, v6
  v_mul_f32 v237, v237, v6
  v_mul_f32 v238, v238, v6
  v_mul_f32 v239, v239, v6
  v_mul_f32 v240, v240, v6
  v_mul_f32 v241, v241, v6
  v_mul_f32 v242, v242, v6
  v_mul_f32 v243, v243, v6
  v_mul_f32 v244, v244, v6
  v_mul_f32 v245, v245, v6
  v_mul_f32 v246, v246, v6
  v_mul_f32 v247, v247, v6
  v_mul_f32 v248, v248, v6
  v_mul_f32 v249, v249, v6
  v_mul_f32 v250, v250, v6
  v_mul_f32 v251, v251, v6
  v_mul_f32 v252, v252, v6
  v_mul_f32 v253, v253, v6
  v_mul_f32 v254, v254, v6
  v_mul_f32 v255, v255, v6
  s_waitcnt lgkmcnt(0)
  s_nop 1
  v_mfma_f32_16x16x32_bf16 v[128:131], a[96:99], v[64:67], v[128:131]
  v_mfma_f32_16x16x32_bf16 v[132:135], a[100:103], v[64:67], v[132:135]
  v_mfma_f32_16x16x32_bf16 v[136:139], a[104:107], v[64:67], v[136:139]
  v_mfma_f32_16x16x32_bf16 v[140:143], a[108:111], v[64:67], v[140:143]
  v_mfma_f32_16x16x32_bf16 v[144:147], a[112:115], v[64:67], v[144:147]
  v_mfma_f32_16x16x32_bf16 v[148:151], a[116:119], v[64:67], v[148:151]
  v_mfma_f32_16x16x32_bf16 v[152:155], a[120:123], v[64:67], v[152:155]
  v_mfma_f32_16x16x32_bf16 v[156:159], a[124:127], v[64:67], v[156:159]
  v_mfma_f32_16x16x32_bf16 v[160:163], a[96:99], v[72:75], v[160:163]
  v_mfma_f32_16x16x32_bf16 v[164:167], a[100:103], v[72:75], v[164:167]
  v_mfma_f32_16x16x32_bf16 v[168:171], a[104:107], v[72:75], v[168:171]
  v_mfma_f32_16x16x32_bf16 v[172:175], a[108:111], v[72:75], v[172:175]
  v_mfma_f32_16x16x32_bf16 v[176:179], a[112:115], v[72:75], v[176:179]
  v_mfma_f32_16x16x32_bf16 v[180:183], a[116:119], v[72:75], v[180:183]
  v_mfma_f32_16x16x32_bf16 v[184:187], a[120:123], v[72:75], v[184:187]
  v_mfma_f32_16x16x32_bf16 v[188:191], a[124:127], v[72:75], v[188:191]
  v_mfma_f32_16x16x32_bf16 v[192:195], a[96:99], v[80:83], v[192:195]
  v_mfma_f32_16x16x32_bf16 v[196:199], a[100:103], v[80:83], v[196:199]
  v_mfma_f32_16x16x32_bf16 v[200:203], a[104:107], v[80:83], v[200:203]
  v_mfma_f32_16x16x32_bf16 v[204:207], a[108:111], v[80:83], v[204:207]
  v_mfma_f32_16x16x32_bf16 v[208:211], a[112:115], v[80:83], v[208:211]
  v_mfma_f32_16x16x32_bf16 v[212:215], a[116:119], v[80:83], v[212:215]
  v_mfma_f32_16x16x32_bf16 v[216:219], a[120:123], v[80:83], v[216:219]
  v_mfma_f32_16x16x32_bf16 v[220:223], a[124:127], v[80:83], v[220:223]
  v_mfma_f32_16x16x32_bf16 v[224:227], a[96:99], v[88:91], v[224:227]
  v_mfma_f32_16x16x32_bf16 v[228:231], a[100:103], v[88:91], v[228:231]
  v_mfma_f32_16x16x32_bf16 v[232:235], a[104:107], v[88:91], v[232:235]
  v_mfma_f32_16x16x32_bf16 v[236:239], a[108:111], v[88:91], v[236:239]
  v_mfma_f32_16x16x32_bf16 v[240:243], a[112:115], v[88:91], v[240:243]
  v_mfma_f32_16x16x32_bf16 v[244:247], a[116:119], v[88:91], v[244:247]
  v_mfma_f32_16x16x32_bf16 v[248:251], a[120:123], v[88:91], v[248:251]
  v_mfma_f32_16x16x32_bf16 v[252:255], a[124:127], v[88:91], v[252:255]
  s_add_u32 s50, s50, 0x2000
  s_cmp_lt_u32 s50, 0x80000
  s_nop 7
  s_cbranch_scc1 L_slow_loop
  v_mov_b32 v5, v8
  s_nop 1
  v_permlane32_swap_b32 v8, v5
  v_add_f32 v8, v8, v5
  v_mov_b32 v5, v8
  s_nop 1
  v_permlane16_swap_b32 v8, v5
  v_add_f32 v8, v8, v5
  v_rcp_f32 v12, v8
  s_nop 0
  v_mov_b32 v13, v12
  v_mov_b32 v5, v9
  s_nop 1
  v_permlane32_swap_b32 v9, v5
  v_add_f32 v9, v9, v5
  v_mov_b32 v5, v9
  s_nop 1
  v_permlane16_swap_b32 v9, v5
  v_add_f32 v9, v9, v5
  v_rcp_f32 v14, v9
  s_nop 0
  v_mov_b32 v15, v14
  v_mov_b32 v5, v10
  s_nop 1
  v_permlane32_swap_b32 v10, v5
  v_add_f32 v10, v10, v5
  v_mov_b32 v5, v10
  s_nop 1
  v_permlane16_swap_b32 v10, v5
  v_add_f32 v10, v10, v5
  v_rcp_f32 v16, v10
  s_nop 0
  v_mov_b32 v17, v16
  v_mov_b32 v5, v11
  s_nop 1
  v_permlane32_swap_b32 v11, v5
  v_add_f32 v11, v11, v5
  v_mov_b32 v5, v11
  s_nop 1
  v_permlane16_swap_b32 v11, v5
  v_add_f32 v11, v11, v5
  v_rcp_f32 v18, v11
  s_nop 0
  v_mov_b32 v19, v18
  v_pk_mul_f32 v[128:129], v[128:129], v[12:13]
  v_pk_mul_f32 v[130:131], v[130:131], v[12:13]
  v_cvt_pk_bf16_f32 v128, v128, v129
  v_cvt_pk_bf16_f32 v129, v130, v131
  ds_write_b64 v28, v[128:129] offset:0
  v_pk_mul_f32 v[132:133], v[132:133], v[12:13]
  v_pk_mul_f32 v[134:135], v[134:135], v[12:13]
  v_cvt_pk_bf16_f32 v132, v132, v133
  v_cvt_pk_bf16_f32 v133, v134, v135
  ds_write_b64 v28, v[132:133] offset:32
  v_pk_mul_f32 v[136:137], v[136:137], v[12:13]
  v_pk_mul_f32 v[138:139], v[138:139], v[12:13]
  v_cvt_pk_bf16_f32 v136, v136, v137
  v_cvt_pk_bf16_f32 v137, v138, v139
  ds_write_b64 v28, v[136:137] offset:64
  v_pk_mul_f32 v[140:141], v[140:141], v[12:13]
  v_pk_mul_f32 v[142:143], v[142:143], v[12:13]
  v_cvt_pk_bf16_f32 v140, v140, v141
  v_cvt_pk_bf16_f32 v141, v142, v143
  ds_write_b64 v28, v[140:141] offset:96
  ds_read_b128 v[132:135], v24 offset:0
  ds_read_b128 v[140:143], v24 offset:3200
  v_pk_mul_f32 v[144:145], v[144:145], v[12:13]
  v_pk_mul_f32 v[146:147], v[146:147], v[12:13]
  v_cvt_pk_bf16_f32 v144, v144, v145
  v_cvt_pk_bf16_f32 v145, v146, v147
  ds_write_b64 v28, v[144:145] offset:128
  v_pk_mul_f32 v[148:149], v[148:149], v[12:13]
  v_pk_mul_f32 v[150:151], v[150:151], v[12:13]
  v_cvt_pk_bf16_f32 v148, v148, v149
  v_cvt_pk_bf16_f32 v149, v150, v151
  ds_write_b64 v28, v[148:149] offset:160
  v_pk_mul_f32 v[152:153], v[152:153], v[12:13]
  v_pk_mul_f32 v[154:155], v[154:155], v[12:13]
  v_cvt_pk_bf16_f32 v152, v152, v153
  v_cvt_pk_bf16_f32 v153, v154, v155
  ds_write_b64 v28, v[152:153] offset:192
  v_pk_mul_f32 v[156:157], v[156:157], v[12:13]
  v_pk_mul_f32 v[158:159], v[158:159], v[12:13]
  v_cvt_pk_bf16_f32 v156, v156, v157
  v_cvt_pk_bf16_f32 v157, v158, v159
  ds_write_b64 v28, v[156:157] offset:224
  ds_read_b128 v[148:151], v24 offset:128
  ds_read_b128 v[156:159], v24 offset:3328
  s_waitcnt lgkmcnt(7)
  buffer_store_dwordx4 v[132:135], v27, s[24:27], s40 offen offset:0 sc0 sc1
  s_waitcnt lgkmcnt(6)
  buffer_store_dwordx4 v[140:143], v27, s[24:27], s40 offen offset:2048 sc0 sc1
  s_waitcnt lgkmcnt(1)
  buffer_store_dwordx4 v[148:151], v27, s[24:27], s40 offen offset:128 sc0 sc1
  s_waitcnt lgkmcnt(0)
  buffer_store_dwordx4 v[156:159], v27, s[24:27], s40 offen offset:2176 sc0 sc1
  v_pk_mul_f32 v[160:161], v[160:161], v[14:15]
  v_pk_mul_f32 v[162:163], v[162:163], v[14:15]
  v_cvt_pk_bf16_f32 v160, v160, v161
  v_cvt_pk_bf16_f32 v161, v162, v163
  ds_write_b64 v28, v[160:161] offset:0
  v_pk_mul_f32 v[164:165], v[164:165], v[14:15]
  v_pk_mul_f32 v[166:167], v[166:167], v[14:15]
  v_cvt_pk_bf16_f32 v164, v164, v165
  v_cvt_pk_bf16_f32 v165, v166, v167
  ds_write_b64 v28, v[164:165] offset:32
  v_pk_mul_f32 v[168:169], v[168:169], v[14:15]
  v_pk_mul_f32 v[170:171], v[170:171], v[14:15]
  v_cvt_pk_bf16_f32 v168, v168, v169
  v_cvt_pk_bf16_f32 v169, v170, v171
  ds_write_b64 v28, v[168:169] offset:64
  v_pk_mul_f32 v[172:173], v[172:173], v[14:15]
  v_pk_mul_f32 v[174:175], v[174:175], v[14:15]
  v_cvt_pk_bf16_f32 v172, v172, v173
  v_cvt_pk_bf16_f32 v173, v174, v175
  ds_write_b64 v28, v[172:173] offset:96
  ds_read_b128 v[164:167], v24 offset:0
  ds_read_b128 v[172:175], v24 offset:3200
  v_pk_mul_f32 v[176:177], v[176:177], v[14:15]
  v_pk_mul_f32 v[178:179], v[178:179], v[14:15]
  v_cvt_pk_bf16_f32 v176, v176, v177
  v_cvt_pk_bf16_f32 v177, v178, v179
  ds_write_b64 v28, v[176:177] offset:128
  v_pk_mul_f32 v[180:181], v[180:181], v[14:15]
  v_pk_mul_f32 v[182:183], v[182:183], v[14:15]
  v_cvt_pk_bf16_f32 v180, v180, v181
  v_cvt_pk_bf16_f32 v181, v182, v183
  ds_write_b64 v28, v[180:181] offset:160
  v_pk_mul_f32 v[184:185], v[184:185], v[14:15]
  v_pk_mul_f32 v[186:187], v[186:187], v[14:15]
  v_cvt_pk_bf16_f32 v184, v184, v185
  v_cvt_pk_bf16_f32 v185, v186, v187
  ds_write_b64 v28, v[184:185] offset:192
  v_pk_mul_f32 v[188:189], v[188:189], v[14:15]
  v_pk_mul_f32 v[190:191], v[190:191], v[14:15]
  v_cvt_pk_bf16_f32 v188, v188, v189
  v_cvt_pk_bf16_f32 v189, v190, v191
  ds_write_b64 v28, v[188:189] offset:224
  ds_read_b128 v[180:183], v24 offset:128
  ds_read_b128 v[188:191], v24 offset:3328
  s_waitcnt lgkmcnt(7)
  buffer_store_dwordx4 v[164:167], v27, s[24:27], s41 offen offset:0 sc0 sc1
  s_waitcnt lgkmcnt(6)
  buffer_store_dwordx4 v[172:175], v27, s[24:27], s41 offen offset:2048 sc0 sc1
  s_waitcnt lgkmcnt(1)
  buffer_store_dwordx4 v[180:183], v27, s[24:27], s41 offen offset:128 sc0 sc1
  s_waitcnt lgkmcnt(0)
  buffer_store_dwordx4 v[188:191], v27, s[24:27], s41 offen offset:2176 sc0 sc1
  v_pk_mul_f32 v[192:193], v[192:193], v[16:17]
  v_pk_mul_f32 v[194:195], v[194:195], v[16:17]
  v_cvt_pk_bf16_f32 v192, v192, v193
  v_cvt_pk_bf16_f32 v193, v194, v195
  ds_write_b64 v28, v[192:193] offset:0
  v_pk_mul_f32 v[196:197], v[196:197], v[16:17]
  v_pk_mul_f32 v[198:199], v[198:199], v[16:17]
  v_cvt_pk_bf16_f32 v196, v196, v197
  v_cvt_pk_bf16_f32 v197, v198, v199
  ds_write_b64 v28, v[196:197] offset:32
  v_pk_mul_f32 v[200:201], v[200:201], v[16:17]
  v_pk_mul_f32 v[202:203], v[202:203], v[16:17]
  v_cvt_pk_bf16_f32 v200, v200, v201
  v_cvt_pk_bf16_f32 v201, v202, v203
  ds_write_b64 v28, v[200:201] offset:64
  v_pk_mul_f32 v[204:205], v[204:205], v[16:17]
  v_pk_mul_f32 v[206:207], v[206:207], v[16:17]
  v_cvt_pk_bf16_f32 v204, v204, v205
  v_cvt_pk_bf16_f32 v205, v206, v207
  ds_write_b64 v28, v[204:205] offset:96
  ds_read_b128 v[196:199], v24 offset:0
  ds_read_b128 v[204:207], v24 offset:3200
  v_pk_mul_f32 v[208:209], v[208:209], v[16:17]
  v_pk_mul_f32 v[210:211], v[210:211], v[16:17]
  v_cvt_pk_bf16_f32 v208, v208, v209
  v_cvt_pk_bf16_f32 v209, v210, v211
  ds_write_b64 v28, v[208:209] offset:128
  v_pk_mul_f32 v[212:213], v[212:213], v[16:17]
  v_pk_mul_f32 v[214:215], v[214:215], v[16:17]
  v_cvt_pk_bf16_f32 v212, v212, v213
  v_cvt_pk_bf16_f32 v213, v214, v215
  ds_write_b64 v28, v[212:213] offset:160
  v_pk_mul_f32 v[216:217], v[216:217], v[16:17]
  v_pk_mul_f32 v[218:219], v[218:219], v[16:17]
  v_cvt_pk_bf16_f32 v216, v216, v217
  v_cvt_pk_bf16_f32 v217, v218, v219
  ds_write_b64 v28, v[216:217] offset:192
  v_pk_mul_f32 v[220:221], v[220:221], v[16:17]
  v_pk_mul_f32 v[222:223], v[222:223], v[16:17]
  v_cvt_pk_bf16_f32 v220, v220, v221
  v_cvt_pk_bf16_f32 v221, v222, v223
  ds_write_b64 v28, v[220:221] offset:224
  ds_read_b128 v[212:215], v24 offset:128
  ds_read_b128 v[220:223], v24 offset:3328
  s_waitcnt lgkmcnt(7)
  buffer_store_dwordx4 v[196:199], v27, s[24:27], s42 offen offset:0 sc0 sc1
  s_waitcnt lgkmcnt(6)
  buffer_store_dwordx4 v[204:207], v27, s[24:27], s42 offen offset:2048 sc0 sc1
  s_waitcnt lgkmcnt(1)
  buffer_store_dwordx4 v[212:215], v27, s[24:27], s42 offen offset:128 sc0 sc1
  s_waitcnt lgkmcnt(0)
  buffer_store_dwordx4 v[220:223], v27, s[24:27], s42 offen offset:2176 sc0 sc1
  v_pk_mul_f32 v[224:225], v[224:225], v[18:19]
  v_pk_mul_f32 v[226:227], v[226:227], v[18:19]
  v_cvt_pk_bf16_f32 v224, v224, v225
  v_cvt_pk_bf16_f32 v225, v226, v227
  ds_write_b64 v28, v[224:225] offset:0
  v_pk_mul_f32 v[228:229], v[228:229], v[18:19]
  v_pk_mul_f32 v[230:231], v[230:231], v[18:19]
  v_cvt_pk_bf16_f32 v228, v228, v229
  v_cvt_pk_bf16_f32 v229, v230, v231
  ds_write_b64 v28, v[228:229] offset:32
  v_pk_mul_f32 v[232:233], v[232:233], v[18:19]
  v_pk_mul_f32 v[234:235], v[234:235], v[18:19]
  v_cvt_pk_bf16_f32 v232, v232, v233
  v_cvt_pk_bf16_f32 v233, v234, v235
  ds_write_b64 v28, v[232:233] offset:64
  v_pk_mul_f32 v[236:237], v[236:237], v[18:19]
  v_pk_mul_f32 v[238:239], v[238:239], v[18:19]
  v_cvt_pk_bf16_f32 v236, v236, v237
  v_cvt_pk_bf16_f32 v237, v238, v239
  ds_write_b64 v28, v[236:237] offset:96
  ds_read_b128 v[228:231], v24 offset:0
  ds_read_b128 v[236:239], v24 offset:3200
  v_pk_mul_f32 v[240:241], v[240:241], v[18:19]
  v_pk_mul_f32 v[242:243], v[242:243], v[18:19]
  v_cvt_pk_bf16_f32 v240, v240, v241
  v_cvt_pk_bf16_f32 v241, v242, v243
  ds_write_b64 v28, v[240:241] offset:128
  v_pk_mul_f32 v[244:245], v[244:245], v[18:19]
  v_pk_mul_f32 v[246:247], v[246:247], v[18:19]
  v_cvt_pk_bf16_f32 v244, v244, v245
  v_cvt_pk_bf16_f32 v245, v246, v247
  ds_write_b64 v28, v[244:245] offset:160
  v_pk_mul_f32 v[248:249], v[248:249], v[18:19]
  v_pk_mul_f32 v[250:251], v[250:251], v[18:19]
  v_cvt_pk_bf16_f32 v248, v248, v249
  v_cvt_pk_bf16_f32 v249, v250, v251
  ds_write_b64 v28, v[248:249] offset:192
  v_pk_mul_f32 v[252:253], v[252:253], v[18:19]
  v_pk_mul_f32 v[254:255], v[254:255], v[18:19]
  v_cvt_pk_bf16_f32 v252, v252, v253
  v_cvt_pk_bf16_f32 v253, v254, v255
  ds_write_b64 v28, v[252:253] offset:224
  ds_read_b128 v[244:247], v24 offset:128
  ds_read_b128 v[252:255], v24 offset:3328
  s_waitcnt lgkmcnt(7)
  buffer_store_dwordx4 v[228:231], v27, s[24:27], s43 offen offset:0 sc0 sc1
  s_waitcnt lgkmcnt(6)
  buffer_store_dwordx4 v[236:239], v27, s[24:27], s43 offen offset:2048 sc0 sc1
  s_waitcnt lgkmcnt(1)
  buffer_store_dwordx4 v[244:247], v27, s[24:27], s43 offen offset:128 sc0 sc1
  s_waitcnt lgkmcnt(0)
  buffer_store_dwordx4 v[252:255], v27, s[24:27], s43 offen offset:2176 sc0 sc1
  s_branch L_fin
.section .rodata,"a"
.p2align 6
.amdhsa_kernel standalone__gqa_softmax__prompt_kernel
  .amdhsa_next_free_vgpr 512
  .amdhsa_next_free_sgpr 96
  .amdhsa_accum_offset 256
  .amdhsa_group_segment_fixed_size 0
  .amdhsa_kernarg_size 48
  .amdhsa_user_sgpr_count 2
  .amdhsa_user_sgpr_kernarg_segment_ptr 1
  .amdhsa_system_sgpr_workgroup_id_x 1
.end_amdhsa_kernel
```
